```python
import torch

def _softmax(x, axis=-1):
    return torch.softmax(x, dim=axis)
def _gelu(x):
    return torch.nn.functional.gelu(x, approximate="tanh")
def _silu(x):
    return torch.nn.functional.silu(x)
def _sigmoid(x):
    return torch.sigmoid(x)
def _layernorm(x, axis=-1, eps=1e-5):
    m = x.mean(dim=axis, keepdim=True)
    v = x.var(dim=axis, keepdim=True, unbiased=False)
    return (x - m) / torch.sqrt(v + eps)
def _scatter_add(tgt, idx, src, axis=0):
    return tgt.clone().index_add_(axis, idx, src)
def _segment_sum(src, seg, n):
    out = torch.zeros((n,) + src.shape[1:], dtype=src.dtype)
    return out.index_add_(0, seg, src)
def _pad(x, pw):
    flat = tuple(v for pair in reversed(pw) for v in pair)
    return torch.nn.functional.pad(x, flat)

kernel_name = 'sequential_preLN__sliding_block_cached__moe_arch_mod__decode'

def setup_inputs():

    _w = (lambda a: (lambda t: t.to(torch.bfloat16) if t.is_floating_point() else t)(torch.as_tensor(a)))
    def _A_setup():
        B, Sq, D = 8, 1, 576
        Hq, Hkv, Sk, Dh = 32, 16, 4096, 128
        assert Hq % Hkv == 0, (Hq, Hkv)
        return {
            "x": _w((lambda *s: torch.randn(*s, dtype=torch.bfloat16) * 0.05)(B, Sq, D)),
            "k_cache": _w((lambda *s: torch.randn(*s, dtype=torch.bfloat16) * 3.2)(B, Hkv, Sk, Dh)),
            "v_cache": _w((lambda *s: torch.randn(*s, dtype=torch.bfloat16) * 0.4)(B, Hkv, Sk, Dh)),
            "wq": _w((lambda *s: torch.randn(*s, dtype=torch.bfloat16) * 3.2)(D, Hq * Dh) * (D ** -0.5)),
            "wo": _w((lambda *s: torch.randn(*s, dtype=torch.bfloat16) * 0.4)(Hq * Dh, D) * ((Hq * Dh) ** -0.5)),
        }
    _A_in = _A_setup()

    def _B_setup():
        B, S, D, F, C = 8, 1, 576, 4608, 1
        return {
            "x": _w((lambda *s: torch.randn(*s, dtype=torch.bfloat16) * 0.05)(B, S, D)),
            "w_r": _w((lambda *s: torch.randn(*s, dtype=torch.bfloat16) * 0.4)(D)),
            "w_gate": _w((lambda *s: torch.randn(*s, dtype=torch.bfloat16) * 0.05)(D, F)),
            "w_up": _w((lambda *s: torch.randn(*s, dtype=torch.bfloat16) * 0.05)(D, F)),
            "w_down": _w((lambda *s: torch.randn(*s, dtype=torch.bfloat16) * 0.05)(F, D)),
        }
    _B_in = _B_setup()

    return {
        "A_x": _A_in["x"],
        "A_k_cache": _A_in["k_cache"],
        "A_v_cache": _A_in["v_cache"],
        "A_wq": _A_in["wq"],
        "A_wo": _A_in["wo"],
        "B_x": _B_in["x"],
        "B_w_r": _B_in["w_r"],
        "B_w_gate": _B_in["w_gate"],
        "B_w_up": _B_in["w_up"],
        "B_w_down": _B_in["w_down"],
    }

def reference(A_x, A_k_cache, A_v_cache, A_wq, A_wo, B_x, B_w_r, B_w_gate, B_w_up, B_w_down):
    def _A_ref(x, k_cache, v_cache, wq, wo):
        B, Sq, D = x.shape
        Hq, Dh = 32, 128
        Hkv, Sk = k_cache.shape[1], k_cache.shape[2]
        W = min(4096, max(256, Sk // 4))
        rep = Hq // Hkv
        q = (lambda x, *d: x.permute(*d))((x @ wq).reshape(B, Sq, Hq, Dh), 0, 2, 1, 3)
        k = (lambda x, n, axis: torch.repeat_interleave(x, n, dim=axis))(k_cache[:, :, Sk - W:, :], rep, axis=1)
        v = (lambda x, n, axis: torch.repeat_interleave(x, n, dim=axis))(v_cache[:, :, Sk - W:, :], rep, axis=1)
        scores = torch.einsum("bhqd,bhkd->bhqk", q, k) * (Dh ** -0.5)
        p = _softmax(scores, axis=-1)
        o = torch.einsum("bhqk,bhkd->bhqd", p, v)
        return (lambda x, *d: x.permute(*d))(o, 0, 2, 1, 3).reshape(B, Sq, Hq * Dh) @ wo

    def _B_ref(x, w_r, w_gate, w_up, w_down):
        B, S, D = x.shape
        C = 1
        r = x @ w_r
        idx = torch.argsort(-r, axis=-1)[:, :C]
        idx_e = (lambda x, n, axis: torch.repeat_interleave(x, n, dim=axis))(idx.reshape(B, C, 1), D, axis=2)
        x_sel = (lambda x, i, axis: torch.take_along_dim(x, i, dim=axis))(x, idx_e, axis=1)
        g = _silu(x_sel @ w_gate)
        u = x_sel @ w_up
        y = (g * u) @ w_down
        r_sel = _sigmoid((lambda x, i, axis: torch.take_along_dim(x, i, dim=axis))(r, idx, axis=1))
        y = y * r_sel.reshape(B, C, 1)
        b_off = (torch.arange(B) * S).reshape(B, 1)
        flat_idx = (idx + b_off).reshape(B * C)
        zero = (x * 0.0).reshape(B * S, D)
        upd = _scatter_add(zero, flat_idx, y.reshape(B * C, D), axis=0)
        return x + upd.reshape(B, S, D)

    x = A_x
    h = x + _A_ref(_layernorm(x, axis=-1), A_k_cache, A_v_cache, A_wq, A_wo)
    h2 = h + _B_ref(_layernorm(h, axis=-1), B_w_r, B_w_gate, B_w_up, B_w_down)
    return h2
```

```asm
; @launch grid=(256,1,1) block=(512,1,1) lds=163840
.amdgcn_target "amdgcn-amd-amdhsa--gfx950"
.text
.globl sequential_preLN__sliding_block_cached__moe_arch_mod__decode_kernel
.p2align 8
.type sequential_preLN__sliding_block_cached__moe_arch_mod__decode_kernel,@function
sequential_preLN__sliding_block_cached__moe_arch_mod__decode_kernel:
    s_cmp_ge_u32 s2, 256
    s_cbranch_scc1 L_end
    s_load_dwordx16 s[16:31], s[0:1], 0
    s_load_dwordx8 s[32:39], s[0:1], 64
    s_load_dwordx2 s[40:41], s[0:1], 96
    v_lshrrev_b32 v4, 6, v0
    v_and_b32 v1, 63, v0
    v_readfirstlane_b32 s3, v4
    v_mov_b32 v2, 0
    v_mov_b32 v3, 1
    v_mov_b32 v13, 0
    s_and_b32 s4, s2, 7
    s_lshr_b32 s5, s2, 3
    s_and_b32 s6, s5, 7
    s_bfe_u32 s7, s5, 0x10003
    s_lshr_b32 s8, s5, 4
    s_lshl_b32 s9, s4, 1
    s_add_u32 s9, s9, s7
    s_lshl_b32 s10, s6, 4
    s_add_u32 s10, s10, s9
    s_lshl_b32 s10, s10, 20
    s_lshl_b32 s11, s8, 17
    s_add_u32 s10, s10, s11
    s_add_u32 s10, s10, 786432
    s_mov_b32 s42, 0x80000
    s_mov_b32 s9, 0
    s_mov_b32 s76, 0xffff0000
    s_mul_i32 s13, s4, 20480
    v_bfe_u32 v5, v1, 2, 2
    v_lshlrev_b32 v5, 8, v5
    v_and_b32 v7, 3, v1
    v_lshl_add_u32 v5, v7, 4, v5
    v_lshrrev_b32 v7, 4, v1
    v_lshl_add_u32 v5, v7, 6, v5
    v_lshlrev_b32 v6, 4, v1
    s_sub_u32 s59, s3, 1
    s_lshl_b32 s11, s59, 11
    s_add_u32 s68, s10, s11
    s_waitcnt lgkmcnt(0)
    s_cmp_eq_u32 s3, 0
    s_cbranch_scc1 L_w0
    s_cmp_ge_u32 s3, 5
    s_cbranch_scc1 L_vw
    s_mov_b32 s48, s18
    s_and_b32 s49, s19, 0xffff
    s_mov_b32 s50, 134217728
    s_mov_b32 s51, 0x20000
    s_setprio 1
    buffer_load_dwordx4 v[16:19], v5, s[48:51], s68 offen offset:0 nt
    s_nop 0
    buffer_load_dwordx4 v[20:23], v5, s[48:51], s68 offen offset:1024 nt
    s_add_u32 s68, s68, 8192
    buffer_load_dwordx4 v[24:27], v5, s[48:51], s68 offen offset:0 nt
    s_nop 0
    buffer_load_dwordx4 v[28:31], v5, s[48:51], s68 offen offset:1024 nt
    s_add_u32 s68, s68, 8192
    s_mov_b32 s11, 2359296
    s_load_dwordx2 s[26:27], s[40:41], s11
    s_mov_b32 s44, s40
    s_and_b32 s45, s41, 0xffff
    s_mov_b32 s46, 536870912
    s_mov_b32 s47, 0x20000
    s_barrier
    buffer_load_dwordx4 v[32:35], v5, s[48:51], s68 offen offset:0 nt
    s_nop 0
    buffer_load_dwordx4 v[36:39], v5, s[48:51], s68 offen offset:1024 nt
    s_add_u32 s68, s68, 8192
    buffer_load_dwordx4 v[40:43], v5, s[48:51], s68 offen offset:0 nt
    s_nop 0
    buffer_load_dwordx4 v[44:47], v5, s[48:51], s68 offen offset:1024 nt
    s_add_u32 s68, s68, 8192
    buffer_load_dwordx4 v[48:51], v5, s[48:51], s68 offen offset:0 nt
    s_nop 0
    buffer_load_dwordx4 v[52:55], v5, s[48:51], s68 offen offset:1024 nt
    s_add_u32 s68, s68, 8192
    buffer_load_dwordx4 v[56:59], v5, s[48:51], s68 offen offset:0 nt
    s_nop 0
    buffer_load_dwordx4 v[60:63], v5, s[48:51], s68 offen offset:1024 nt
    s_add_u32 s68, s68, 8192
    buffer_load_dwordx4 v[64:67], v5, s[48:51], s68 offen offset:0 nt
    s_nop 0
    buffer_load_dwordx4 v[68:71], v5, s[48:51], s68 offen offset:1024 nt
    s_add_u32 s68, s68, 8192
    buffer_load_dwordx4 v[72:75], v5, s[48:51], s68 offen offset:0 nt
    s_nop 0
    buffer_load_dwordx4 v[76:79], v5, s[48:51], s68 offen offset:1024 nt
    s_add_u32 s68, s68, 8192
    buffer_load_dwordx4 v[80:83], v5, s[48:51], s68 offen offset:0 nt
    s_nop 0
    buffer_load_dwordx4 v[84:87], v5, s[48:51], s68 offen offset:1024 nt
    s_add_u32 s68, s68, 8192
    buffer_load_dwordx4 v[88:91], v5, s[48:51], s68 offen offset:0 nt
    s_nop 0
    buffer_load_dwordx4 v[92:95], v5, s[48:51], s68 offen offset:1024 nt
    s_add_u32 s68, s68, 8192
    buffer_load_dwordx4 v[96:99], v5, s[48:51], s68 offen offset:0 nt
    s_nop 0
    buffer_load_dwordx4 v[100:103], v5, s[48:51], s68 offen offset:1024 nt
    s_add_u32 s68, s68, 8192
    buffer_load_dwordx4 v[104:107], v5, s[48:51], s68 offen offset:0 nt
    s_nop 0
    buffer_load_dwordx4 v[108:111], v5, s[48:51], s68 offen offset:1024 nt
    s_add_u32 s68, s68, 8192
    buffer_load_dwordx4 v[112:115], v5, s[48:51], s68 offen offset:0 nt
    s_nop 0
    buffer_load_dwordx4 v[116:119], v5, s[48:51], s68 offen offset:1024 nt
    s_add_u32 s68, s68, 8192
    s_mov_b64 exec, 1
    ds_add_u32 v2, v3 offset:52
    s_mov_b64 exec, -1
    buffer_load_dwordx4 v[120:123], v5, s[48:51], s68 offen offset:0 nt
    s_nop 0
    buffer_load_dwordx4 v[124:127], v5, s[48:51], s68 offen offset:1024 nt
    s_add_u32 s68, s68, 8192
    buffer_load_dwordx4 v[128:131], v5, s[48:51], s68 offen offset:0 nt
    s_nop 0
    buffer_load_dwordx4 v[132:135], v5, s[48:51], s68 offen offset:1024 nt
    s_add_u32 s68, s68, 8192
    buffer_load_dwordx4 v[136:139], v5, s[48:51], s68 offen offset:0 nt
    s_nop 0
    buffer_load_dwordx4 v[140:143], v5, s[48:51], s68 offen offset:1024 nt
    s_add_u32 s68, s68, 8192
    s_waitcnt lgkmcnt(0)
    s_add_u32 s26, s26, 0x9e3779b9
    s_addc_u32 s27, s27, 0x7f4a7c15
    s_cmp_lg_u32 s3, 4
    s_cbranch_scc1 L_kq
    s_setprio 3
    s_lshl_b32 s14, s4, 17
    s_lshl_b32 s11, s6, 12
    s_add_u32 s14, s14, s11
    s_lshl_b32 s11, s7, 11
    s_add_u32 s14, s14, s11
    s_add_u32 s15, s14, 32768
    s_add_u32 s56, s14, 65536
    v_mov_b32 v10, v6
    v_and_b32 v11, 31, v1
    v_lshlrev_b32 v11, 7, v11
    s_lshl_b32 s57, s4, 12
    s_add_u32 s57, s57, 2490368
    s_getreg_b32 s58, hwreg(HW_REG_XCC_ID)
    s_and_b32 s58, s58, 7
    s_mov_b32 s43, 0
    v_mov_b32 v218, 0
    v_mov_b32 v219, 0
    buffer_load_dwordx4 v[192:195], v10, s[44:47], s14 offen offset:0 nt
    buffer_load_dwordx4 v[196:199], v10, s[44:47], s14 offen offset:1024 nt
    buffer_load_dwordx4 v[200:203], v10, s[44:47], s15 offen offset:0 nt
    buffer_load_dwordx4 v[204:207], v10, s[44:47], s15 offen offset:1024 nt
    buffer_load_dwordx4 v[208:211], v10, s[44:47], s56 offen offset:0 nt
    buffer_load_dwordx4 v[212:215], v10, s[44:47], s56 offen offset:1024 nt
    buffer_load_dwordx4 v[216:219], v11, s[44:47], s57 offen
    s_waitcnt vmcnt(6)
    v_cmp_ne_u64 s[60:61], s[26:27], v[194:195]
    s_waitcnt vmcnt(5)
    v_cmp_ne_u64 vcc, s[26:27], v[198:199]
    s_nop 0
    s_or_b64 s[60:61], s[60:61], vcc
    s_waitcnt vmcnt(4)
    v_cmp_ne_u64 vcc, s[26:27], v[202:203]
    s_nop 0
    s_or_b64 s[60:61], s[60:61], vcc
    s_waitcnt vmcnt(3)
    v_cmp_ne_u64 vcc, s[26:27], v[206:207]
    s_nop 0
    s_or_b64 s[60:61], s[60:61], vcc
    s_waitcnt vmcnt(2)
    v_cmp_ne_u64 vcc, s[26:27], v[210:211]
    s_nop 0
    s_or_b64 s[60:61], s[60:61], vcc
    s_waitcnt vmcnt(1)
    v_cmp_ne_u64 vcc, s[26:27], v[214:215]
    s_nop 0
    s_or_b64 s[60:61], s[60:61], vcc
    s_cmp_eq_u64 s[60:61], 0
    s_cbranch_scc1 L_q_ok
    buffer_load_dwordx4 v[192:195], v10, s[44:47], s14 offen offset:0 nt
    buffer_load_dwordx4 v[196:199], v10, s[44:47], s14 offen offset:1024 nt
    buffer_load_dwordx4 v[200:203], v10, s[44:47], s15 offen offset:0 nt
    buffer_load_dwordx4 v[204:207], v10, s[44:47], s15 offen offset:1024 nt
    buffer_load_dwordx4 v[208:211], v10, s[44:47], s56 offen offset:0 nt
    buffer_load_dwordx4 v[212:215], v10, s[44:47], s56 offen offset:1024 nt
    s_waitcnt vmcnt(5)
    v_cmp_ne_u64 s[60:61], s[26:27], v[194:195]
    s_waitcnt vmcnt(4)
    v_cmp_ne_u64 vcc, s[26:27], v[198:199]
    s_nop 0
    s_or_b64 s[60:61], s[60:61], vcc
    s_waitcnt vmcnt(3)
    v_cmp_ne_u64 vcc, s[26:27], v[202:203]
    s_nop 0
    s_or_b64 s[60:61], s[60:61], vcc
    s_waitcnt vmcnt(2)
    v_cmp_ne_u64 vcc, s[26:27], v[206:207]
    s_nop 0
    s_or_b64 s[60:61], s[60:61], vcc
    s_waitcnt vmcnt(1)
    v_cmp_ne_u64 vcc, s[26:27], v[210:211]
    s_nop 0
    s_or_b64 s[60:61], s[60:61], vcc
    s_waitcnt vmcnt(0)
    v_cmp_ne_u64 vcc, s[26:27], v[214:215]
    s_nop 0
    s_or_b64 s[60:61], s[60:61], vcc
    s_cmp_eq_u64 s[60:61], 0
    s_cbranch_scc1 L_q_ok
    buffer_load_dwordx4 v[192:195], v10, s[44:47], s14 offen offset:0 nt
    buffer_load_dwordx4 v[196:199], v10, s[44:47], s14 offen offset:1024 nt
    buffer_load_dwordx4 v[200:203], v10, s[44:47], s15 offen offset:0 nt
    buffer_load_dwordx4 v[204:207], v10, s[44:47], s15 offen offset:1024 nt
    buffer_load_dwordx4 v[208:211], v10, s[44:47], s56 offen offset:0 nt
    buffer_load_dwordx4 v[212:215], v10, s[44:47], s56 offen offset:1024 nt
    s_waitcnt vmcnt(5)
    v_cmp_ne_u64 s[60:61], s[26:27], v[194:195]
    s_waitcnt vmcnt(4)
    v_cmp_ne_u64 vcc, s[26:27], v[198:199]
    s_nop 0
    s_or_b64 s[60:61], s[60:61], vcc
    s_waitcnt vmcnt(3)
    v_cmp_ne_u64 vcc, s[26:27], v[202:203]
    s_nop 0
    s_or_b64 s[60:61], s[60:61], vcc
    s_waitcnt vmcnt(2)
    v_cmp_ne_u64 vcc, s[26:27], v[206:207]
    s_nop 0
    s_or_b64 s[60:61], s[60:61], vcc
    s_waitcnt vmcnt(1)
    v_cmp_ne_u64 vcc, s[26:27], v[210:211]
    s_nop 0
    s_or_b64 s[60:61], s[60:61], vcc
    s_waitcnt vmcnt(0)
    v_cmp_ne_u64 vcc, s[26:27], v[214:215]
    s_nop 0
    s_or_b64 s[60:61], s[60:61], vcc
    s_cmp_eq_u64 s[60:61], 0
    s_cbranch_scc1 L_q_ok
L_qp:
    buffer_load_dwordx4 v[192:195], v10, s[44:47], s14 offen offset:0 sc1
    buffer_load_dwordx4 v[196:199], v10, s[44:47], s14 offen offset:1024 sc1
    buffer_load_dwordx4 v[200:203], v10, s[44:47], s15 offen offset:0 sc1
    buffer_load_dwordx4 v[204:207], v10, s[44:47], s15 offen offset:1024 sc1
    buffer_load_dwordx4 v[208:211], v10, s[44:47], s56 offen offset:0 sc1
    buffer_load_dwordx4 v[212:215], v10, s[44:47], s56 offen offset:1024 sc1
    buffer_load_dwordx4 v[216:219], v11, s[44:47], s57 offen sc1
    s_waitcnt vmcnt(6)
    v_cmp_ne_u64 s[60:61], s[26:27], v[194:195]
    s_waitcnt vmcnt(5)
    v_cmp_ne_u64 vcc, s[26:27], v[198:199]
    s_nop 0
    s_or_b64 s[60:61], s[60:61], vcc
    s_waitcnt vmcnt(4)
    v_cmp_ne_u64 vcc, s[26:27], v[202:203]
    s_nop 0
    s_or_b64 s[60:61], s[60:61], vcc
    s_waitcnt vmcnt(3)
    v_cmp_ne_u64 vcc, s[26:27], v[206:207]
    s_nop 0
    s_or_b64 s[60:61], s[60:61], vcc
    s_waitcnt vmcnt(2)
    v_cmp_ne_u64 vcc, s[26:27], v[210:211]
    s_nop 0
    s_or_b64 s[60:61], s[60:61], vcc
    s_waitcnt vmcnt(1)
    v_cmp_ne_u64 vcc, s[26:27], v[214:215]
    s_nop 0
    s_or_b64 s[60:61], s[60:61], vcc
    s_cmp_eq_u64 s[60:61], 0
    s_cbranch_scc1 L_q_ok
    s_waitcnt vmcnt(0)
    v_cmp_ne_u64 vcc, s[26:27], v[218:219]
    s_cbranch_vccnz L_q_ae
    v_cmp_ne_u32 vcc, s58, v216
    s_nop 0
    s_cmp_eq_u64 vcc, 0
    s_cselect_b32 s43, 1, 2
    v_mov_b32 v4, s43
    ds_write_b32 v2, v4 offset:32
L_q_ae:
    s_cmp_eq_u32 s43, 2
    s_cbranch_scc0 L_q_r
    v_add_u32 v10, 3145728, v6
L_q_r:
    s_sub_u32 s42, s42, 1
    s_cbranch_scc0 L_qp
    s_branch L_abort
L_q_ok:
    v_pk_add_f32 v[192:193], v[192:193], v[200:201]
    v_pk_add_f32 v[192:193], v[192:193], v[208:209]
    v_cvt_pk_bf16_f32 v8, v192, v193
    v_pk_add_f32 v[196:197], v[196:197], v[204:205]
    v_pk_add_f32 v[196:197], v[196:197], v[212:213]
    v_cvt_pk_bf16_f32 v9, v196, v197
    v_lshlrev_b32 v10, 2, v1
    ds_write_b32 v10, v8 offset:256
    ds_write_b32 v10, v9 offset:512
    s_mov_b64 exec, 1
    ds_add_u32 v2, v3 offset:0
    s_mov_b64 exec, -1
    s_waitcnt vmcnt(0)
    v_cmp_ne_u64 vcc, s[26:27], v[218:219]
    s_cbranch_vccnz L_q_ae2
    v_cmp_ne_u32 vcc, s58, v216
    s_nop 0
    s_cmp_eq_u64 vcc, 0
    s_cselect_b32 s43, 1, 2
    v_mov_b32 v4, s43
    ds_write_b32 v2, v4 offset:32
L_q_ae2:
L_kq:
    v_bfe_u32 v8, v1, 3, 1
    v_lshlrev_b32 v8, 8, v8
    v_lshrrev_b32 v9, 4, v1
    v_lshl_add_u32 v8, v9, 6, v8
    v_and_b32 v9, 3, v1
    v_lshl_add_u32 v8, v9, 4, v8
    s_mov_b32 s72, 0xaaaaaaaa
    s_mov_b32 s73, 0xaaaaaaaa
    s_mov_b32 s74, 0xcccccccc
    s_mov_b32 s75, 0xcccccccc
    s_mov_b32 s70, 0xf0f0f0f0
    s_mov_b32 s71, 0xf0f0f0f0
    s_mov_b32 s14, 0x3db504f3
    s_mov_b32 s15, 0x3fb8aa3b
Lfw_1:
    ds_read_b32 v4, v2 offset:0
    s_waitcnt lgkmcnt(0)
    v_readfirstlane_b32 s11, v4
    s_nop 0
    s_cmp_ge_u32 s11, 1
    s_cbranch_scc1 Lfd_2
    s_sleep 1
    s_sub_u32 s42, s42, 1
    s_cbranch_scc0 Lfw_1
    s_branch L_abort
Lfd_2:
    ds_read_b128 v[180:183], v8 offset:256
    s_waitcnt lgkmcnt(0)
    v_cndmask_b32 v176, v180, 0, s[70:71]
    v_cndmask_b32 v180, 0, v180, s[70:71]
    v_cndmask_b32 v177, v181, 0, s[70:71]
    v_cndmask_b32 v181, 0, v181, s[70:71]
    v_cndmask_b32 v178, v182, 0, s[70:71]
    v_cndmask_b32 v182, 0, v182, s[70:71]
    v_cndmask_b32 v179, v183, 0, s[70:71]
    v_cndmask_b32 v183, 0, v183, s[70:71]
    s_waitcnt vmcnt(30)
    v_mfma_f32_16x16x32_bf16 v[192:195], v[16:19], v[176:179], 0
    v_mfma_f32_16x16x32_bf16 v[192:195], v[20:23], v[180:183], v[192:195]
    s_waitcnt vmcnt(28)
    v_mfma_f32_16x16x32_bf16 v[196:199], v[24:27], v[176:179], 0
    v_mfma_f32_16x16x32_bf16 v[196:199], v[28:31], v[180:183], v[196:199]
    s_waitcnt vmcnt(26)
    v_mfma_f32_16x16x32_bf16 v[200:203], v[32:35], v[176:179], 0
    v_mfma_f32_16x16x32_bf16 v[200:203], v[36:39], v[180:183], v[200:203]
    s_waitcnt vmcnt(24)
    v_mfma_f32_16x16x32_bf16 v[204:207], v[40:43], v[176:179], 0
    v_mfma_f32_16x16x32_bf16 v[204:207], v[44:47], v[180:183], v[204:207]
    s_waitcnt vmcnt(22)
    v_mfma_f32_16x16x32_bf16 v[208:211], v[48:51], v[176:179], 0
    v_mfma_f32_16x16x32_bf16 v[208:211], v[52:55], v[180:183], v[208:211]
    s_waitcnt vmcnt(20)
    v_mfma_f32_16x16x32_bf16 v[212:215], v[56:59], v[176:179], 0
    v_mfma_f32_16x16x32_bf16 v[212:215], v[60:63], v[180:183], v[212:215]
    v_mov_b32_dpp v184, v192 quad_perm:[0,0,0,0] row_mask:0xf bank_mask:0xf
    v_mov_b32_dpp v185, v196 quad_perm:[0,0,0,0] row_mask:0xf bank_mask:0xf
    v_mov_b32_dpp v186, v200 quad_perm:[0,0,0,0] row_mask:0xf bank_mask:0xf
    v_mov_b32_dpp v187, v204 quad_perm:[0,0,0,0] row_mask:0xf bank_mask:0xf
    v_add_f32_dpp v184, v193, v184 quad_perm:[1,1,1,1] row_mask:0xf bank_mask:0xf
    v_add_f32_dpp v185, v197, v185 quad_perm:[1,1,1,1] row_mask:0xf bank_mask:0xf
    v_add_f32_dpp v186, v201, v186 quad_perm:[1,1,1,1] row_mask:0xf bank_mask:0xf
    v_add_f32_dpp v187, v205, v187 quad_perm:[1,1,1,1] row_mask:0xf bank_mask:0xf
    v_add_f32_dpp v184, v194, v184 quad_perm:[2,2,2,2] row_mask:0xf bank_mask:0xf
    v_add_f32_dpp v185, v198, v185 quad_perm:[2,2,2,2] row_mask:0xf bank_mask:0xf
    v_add_f32_dpp v186, v202, v186 quad_perm:[2,2,2,2] row_mask:0xf bank_mask:0xf
    v_add_f32_dpp v187, v206, v187 quad_perm:[2,2,2,2] row_mask:0xf bank_mask:0xf
    v_add_f32_dpp v184, v195, v184 quad_perm:[3,3,3,3] row_mask:0xf bank_mask:0xf
    v_add_f32_dpp v185, v199, v185 quad_perm:[3,3,3,3] row_mask:0xf bank_mask:0xf
    v_add_f32_dpp v186, v203, v186 quad_perm:[3,3,3,3] row_mask:0xf bank_mask:0xf
    v_add_f32_dpp v187, v207, v187 quad_perm:[3,3,3,3] row_mask:0xf bank_mask:0xf
    v_cndmask_b32 v184, v184, v185, s[72:73]
    v_cndmask_b32 v186, v186, v187, s[72:73]
    v_cndmask_b32 v160, v184, v186, s[74:75]
    s_waitcnt vmcnt(18)
    v_mfma_f32_16x16x32_bf16 v[216:219], v[64:67], v[176:179], 0
    v_mfma_f32_16x16x32_bf16 v[216:219], v[68:71], v[180:183], v[216:219]
    s_waitcnt vmcnt(16)
    v_mfma_f32_16x16x32_bf16 v[220:223], v[72:75], v[176:179], 0
    v_mfma_f32_16x16x32_bf16 v[220:223], v[76:79], v[180:183], v[220:223]
    s_waitcnt vmcnt(14)
    v_mfma_f32_16x16x32_bf16 v[192:195], v[80:83], v[176:179], 0
    v_mfma_f32_16x16x32_bf16 v[192:195], v[84:87], v[180:183], v[192:195]
    s_waitcnt vmcnt(12)
    v_mfma_f32_16x16x32_bf16 v[196:199], v[88:91], v[176:179], 0
    v_mfma_f32_16x16x32_bf16 v[196:199], v[92:95], v[180:183], v[196:199]
    v_mov_b32_dpp v184, v208 quad_perm:[0,0,0,0] row_mask:0xf bank_mask:0xf
    v_mov_b32_dpp v185, v212 quad_perm:[0,0,0,0] row_mask:0xf bank_mask:0xf
    v_mov_b32_dpp v186, v216 quad_perm:[0,0,0,0] row_mask:0xf bank_mask:0xf
    v_mov_b32_dpp v187, v220 quad_perm:[0,0,0,0] row_mask:0xf bank_mask:0xf
    v_add_f32_dpp v184, v209, v184 quad_perm:[1,1,1,1] row_mask:0xf bank_mask:0xf
    v_add_f32_dpp v185, v213, v185 quad_perm:[1,1,1,1] row_mask:0xf bank_mask:0xf
    v_add_f32_dpp v186, v217, v186 quad_perm:[1,1,1,1] row_mask:0xf bank_mask:0xf
    v_add_f32_dpp v187, v221, v187 quad_perm:[1,1,1,1] row_mask:0xf bank_mask:0xf
    v_add_f32_dpp v184, v210, v184 quad_perm:[2,2,2,2] row_mask:0xf bank_mask:0xf
    v_add_f32_dpp v185, v214, v185 quad_perm:[2,2,2,2] row_mask:0xf bank_mask:0xf
    v_add_f32_dpp v186, v218, v186 quad_perm:[2,2,2,2] row_mask:0xf bank_mask:0xf
    v_add_f32_dpp v187, v222, v187 quad_perm:[2,2,2,2] row_mask:0xf bank_mask:0xf
    v_add_f32_dpp v184, v211, v184 quad_perm:[3,3,3,3] row_mask:0xf bank_mask:0xf
    v_add_f32_dpp v185, v215, v185 quad_perm:[3,3,3,3] row_mask:0xf bank_mask:0xf
    v_add_f32_dpp v186, v219, v186 quad_perm:[3,3,3,3] row_mask:0xf bank_mask:0xf
    v_add_f32_dpp v187, v223, v187 quad_perm:[3,3,3,3] row_mask:0xf bank_mask:0xf
    v_cndmask_b32 v184, v184, v185, s[72:73]
    v_cndmask_b32 v186, v186, v187, s[72:73]
    v_cndmask_b32 v161, v184, v186, s[74:75]
    s_waitcnt vmcnt(10)
    v_mfma_f32_16x16x32_bf16 v[200:203], v[96:99], v[176:179], 0
    v_mfma_f32_16x16x32_bf16 v[200:203], v[100:103], v[180:183], v[200:203]
    s_waitcnt vmcnt(8)
    v_mfma_f32_16x16x32_bf16 v[204:207], v[104:107], v[176:179], 0
    v_mfma_f32_16x16x32_bf16 v[204:207], v[108:111], v[180:183], v[204:207]
    s_waitcnt vmcnt(6)
    v_mfma_f32_16x16x32_bf16 v[208:211], v[112:115], v[176:179], 0
    v_mfma_f32_16x16x32_bf16 v[208:211], v[116:119], v[180:183], v[208:211]
    s_waitcnt vmcnt(4)
    v_mfma_f32_16x16x32_bf16 v[212:215], v[120:123], v[176:179], 0
    v_mfma_f32_16x16x32_bf16 v[212:215], v[124:127], v[180:183], v[212:215]
    v_mov_b32_dpp v184, v192 quad_perm:[0,0,0,0] row_mask:0xf bank_mask:0xf
    v_mov_b32_dpp v185, v196 quad_perm:[0,0,0,0] row_mask:0xf bank_mask:0xf
    v_mov_b32_dpp v186, v200 quad_perm:[0,0,0,0] row_mask:0xf bank_mask:0xf
    v_mov_b32_dpp v187, v204 quad_perm:[0,0,0,0] row_mask:0xf bank_mask:0xf
    v_add_f32_dpp v184, v193, v184 quad_perm:[1,1,1,1] row_mask:0xf bank_mask:0xf
    v_add_f32_dpp v185, v197, v185 quad_perm:[1,1,1,1] row_mask:0xf bank_mask:0xf
    v_add_f32_dpp v186, v201, v186 quad_perm:[1,1,1,1] row_mask:0xf bank_mask:0xf
    v_add_f32_dpp v187, v205, v187 quad_perm:[1,1,1,1] row_mask:0xf bank_mask:0xf
    v_add_f32_dpp v184, v194, v184 quad_perm:[2,2,2,2] row_mask:0xf bank_mask:0xf
    v_add_f32_dpp v185, v198, v185 quad_perm:[2,2,2,2] row_mask:0xf bank_mask:0xf
    v_add_f32_dpp v186, v202, v186 quad_perm:[2,2,2,2] row_mask:0xf bank_mask:0xf
    v_add_f32_dpp v187, v206, v187 quad_perm:[2,2,2,2] row_mask:0xf bank_mask:0xf
    v_add_f32_dpp v184, v195, v184 quad_perm:[3,3,3,3] row_mask:0xf bank_mask:0xf
    v_add_f32_dpp v185, v199, v185 quad_perm:[3,3,3,3] row_mask:0xf bank_mask:0xf
    v_add_f32_dpp v186, v203, v186 quad_perm:[3,3,3,3] row_mask:0xf bank_mask:0xf
    v_add_f32_dpp v187, v207, v187 quad_perm:[3,3,3,3] row_mask:0xf bank_mask:0xf
    v_cndmask_b32 v184, v184, v185, s[72:73]
    v_cndmask_b32 v186, v186, v187, s[72:73]
    v_cndmask_b32 v162, v184, v186, s[74:75]
    s_waitcnt vmcnt(2)
    v_mfma_f32_16x16x32_bf16 v[216:219], v[128:131], v[176:179], 0
    v_mfma_f32_16x16x32_bf16 v[216:219], v[132:135], v[180:183], v[216:219]
    s_waitcnt vmcnt(0)
    v_mfma_f32_16x16x32_bf16 v[220:223], v[136:139], v[176:179], 0
    v_mfma_f32_16x16x32_bf16 v[220:223], v[140:143], v[180:183], v[220:223]
    v_mov_b32_dpp v184, v208 quad_perm:[0,0,0,0] row_mask:0xf bank_mask:0xf
    v_mov_b32_dpp v185, v212 quad_perm:[0,0,0,0] row_mask:0xf bank_mask:0xf
    s_nop 2
    v_mov_b32_dpp v186, v216 quad_perm:[0,0,0,0] row_mask:0xf bank_mask:0xf
    s_nop 1
    v_mov_b32_dpp v187, v220 quad_perm:[0,0,0,0] row_mask:0xf bank_mask:0xf
    v_add_f32_dpp v184, v209, v184 quad_perm:[1,1,1,1] row_mask:0xf bank_mask:0xf
    v_add_f32_dpp v185, v213, v185 quad_perm:[1,1,1,1] row_mask:0xf bank_mask:0xf
    v_add_f32_dpp v186, v217, v186 quad_perm:[1,1,1,1] row_mask:0xf bank_mask:0xf
    v_add_f32_dpp v187, v221, v187 quad_perm:[1,1,1,1] row_mask:0xf bank_mask:0xf
    v_add_f32_dpp v184, v210, v184 quad_perm:[2,2,2,2] row_mask:0xf bank_mask:0xf
    v_add_f32_dpp v185, v214, v185 quad_perm:[2,2,2,2] row_mask:0xf bank_mask:0xf
    v_add_f32_dpp v186, v218, v186 quad_perm:[2,2,2,2] row_mask:0xf bank_mask:0xf
    v_add_f32_dpp v187, v222, v187 quad_perm:[2,2,2,2] row_mask:0xf bank_mask:0xf
    v_add_f32_dpp v184, v211, v184 quad_perm:[3,3,3,3] row_mask:0xf bank_mask:0xf
    v_add_f32_dpp v185, v215, v185 quad_perm:[3,3,3,3] row_mask:0xf bank_mask:0xf
    v_add_f32_dpp v186, v219, v186 quad_perm:[3,3,3,3] row_mask:0xf bank_mask:0xf
    v_add_f32_dpp v187, v223, v187 quad_perm:[3,3,3,3] row_mask:0xf bank_mask:0xf
    v_cndmask_b32 v184, v184, v185, s[72:73]
    v_cndmask_b32 v186, v186, v187, s[72:73]
    v_cndmask_b32 v163, v184, v186, s[74:75]
    v_cvt_pk_bf16_f32 v10, v160, v161
    v_cvt_pk_bf16_f32 v11, v162, v163
    v_lshlrev_b32 v160, 16, v10
    v_and_b32 v161, s76, v10
    v_lshlrev_b32 v162, 16, v11
    v_and_b32 v163, s76, v11
    v_mul_f32 v160, s14, v160
    v_mul_f32 v161, s14, v161
    v_mul_f32 v162, s14, v162
    v_mul_f32 v163, s14, v163
    v_cvt_pk_bf16_f32 v10, v160, v161
    v_cvt_pk_bf16_f32 v11, v162, v163
    v_lshlrev_b32 v160, 16, v10
    v_and_b32 v161, s76, v10
    v_lshlrev_b32 v162, 16, v11
    v_and_b32 v163, s76, v11
    v_max3_f32 v12, v160, v161, v162
    v_max_f32 v12, v12, v163
    s_nop 1
    v_max_f32_dpp v12, v12, v12 quad_perm:[1,0,3,2] row_mask:0xf bank_mask:0xf
    s_nop 1
    v_max_f32_dpp v12, v12, v12 quad_perm:[2,3,0,1] row_mask:0xf bank_mask:0xf
    s_nop 1
    v_max_f32_dpp v12, v12, v12 row_half_mirror row_mask:0xf bank_mask:0xf
    v_mov_b32 v14, v12
    s_nop 1
    v_permlane16_swap_b32 v12, v14
    v_max_f32 v12, v12, v14
    v_mov_b32 v14, v12
    s_nop 1
    v_permlane32_swap_b32 v12, v14
    v_max_f32 v12, v12, v14
    v_mul_f32 v15, s15, v12
    v_fma_f32 v184, v160, s15, -v15
    v_fma_f32 v185, v161, s15, -v15
    v_fma_f32 v186, v162, s15, -v15
    v_fma_f32 v187, v163, s15, -v15
    v_exp_f32 v184, v184
    v_exp_f32 v185, v185
    v_exp_f32 v186, v186
    v_exp_f32 v187, v187
    s_nop 0
    v_pk_add_f32 v[184:185], v[184:185], v[186:187]
    v_add_f32 v13, v184, v185
    s_nop 1
    v_add_f32_dpp v13, v13, v13 quad_perm:[1,0,3,2] row_mask:0xf bank_mask:0xf
    s_nop 1
    v_add_f32_dpp v13, v13, v13 quad_perm:[2,3,0,1] row_mask:0xf bank_mask:0xf
    s_nop 1
    v_add_f32_dpp v13, v13, v13 row_half_mirror row_mask:0xf bank_mask:0xf
    v_mov_b32 v14, v13
    s_nop 1
    v_permlane16_swap_b32 v13, v14
    v_add_f32 v13, v13, v14
    v_mov_b32 v14, v13
    s_nop 1
    v_permlane32_swap_b32 v13, v14
    v_add_f32 v13, v13, v14
    v_and_b32 v8, 8, v1
    s_lshl_b32 s11, s59, 4
    v_add_u32 v9, s11, v8
    s_mov_b64 exec, 0x101
    ds_write_b64 v9, v[12:13] offset:768
    s_mov_b64 exec, 1
    ds_add_u32 v2, v3 offset:8
    s_mov_b64 exec, -1
    v_bfe_u32 v16, v1, 3, 1
    v_lshlrev_b32 v16, 11, v16
    v_lshrrev_b32 v9, 4, v1
    v_lshl_add_u32 v16, v9, 9, v16
    v_bfe_u32 v9, v1, 2, 1
    v_lshl_add_u32 v16, v9, 7, v16
    v_and_b32 v9, 3, v1
    v_lshl_add_u32 v16, v9, 3, v16
    s_and_b32 s11, s59, 1
    s_lshl_b32 s11, s11, 8
    s_lshr_b32 s12, s59, 1
    s_lshl_b32 s12, s12, 2
    s_add_u32 s11, s11, s12
    v_add_u32 v16, s11, v16
    s_cmp_eq_u32 s3, 4
    s_cbranch_scc1 L_ml
    s_sub_u32 s11, s5, 18
    s_cmp_ge_u32 s11, 9
    s_cbranch_scc1 L_kp
    s_mov_b32 s52, s24
    s_and_b32 s53, s25, 0xffff
    s_mov_b32 s54, 4718592
    s_mov_b32 s55, 0x20000
    s_sub_u32 s77, s5, 18
    s_lshl_b32 s77, s77, 7
    v_lshrrev_b32 v11, 3, v1
    s_mov_b32 s11, 1152
    v_mul_lo_u32 v9, v11, s11
    v_and_b32 v11, 2, v11
    v_and_b32 v12, 7, v1
    v_xor_b32 v12, v12, v11
    v_xor_b32 v11, 4, v12
    v_lshl_add_u32 v10, v11, 4, v9
    v_lshl_add_u32 v9, v12, 4, v9
    s_sub_u32 s12, s3, 1
    s_mul_i32 s14, s4, 589824
    s_add_u32 s14, s14, s77
    s_mul_i32 s15, s12, 202752
    s_add_u32 s14, s14, s15
    s_mul_i32 s15, s12, 22528
    s_add_u32 s15, s15, 24576
    s_mov_b32 m0, s15
    s_nop 0
    buffer_load_dwordx4 v9, s[52:55], s14 offen nt lds
    s_add_u32 s14, s14, 9216
    s_add_u32 s15, s15, 1024
    s_mov_b32 m0, s15
    s_nop 0
    buffer_load_dwordx4 v10, s[52:55], s14 offen nt lds
    s_add_u32 s14, s14, 9216
    s_add_u32 s15, s15, 1024
    s_mov_b32 m0, s15
    s_nop 0
    buffer_load_dwordx4 v9, s[52:55], s14 offen nt lds
    s_add_u32 s14, s14, 9216
    s_add_u32 s15, s15, 1024
    s_mov_b32 m0, s15
    s_nop 0
    buffer_load_dwordx4 v10, s[52:55], s14 offen nt lds
    s_add_u32 s14, s14, 9216
    s_add_u32 s15, s15, 1024
    s_mov_b32 m0, s15
    s_nop 0
    buffer_load_dwordx4 v9, s[52:55], s14 offen nt lds
    s_add_u32 s14, s14, 9216
    s_add_u32 s15, s15, 1024
    s_mov_b32 m0, s15
    s_nop 0
    buffer_load_dwordx4 v10, s[52:55], s14 offen nt lds
    s_add_u32 s14, s14, 9216
    s_add_u32 s15, s15, 1024
    s_mov_b32 m0, s15
    s_nop 0
    buffer_load_dwordx4 v9, s[52:55], s14 offen nt lds
    s_add_u32 s14, s14, 9216
    s_add_u32 s15, s15, 1024
    s_mov_b32 m0, s15
    s_nop 0
    buffer_load_dwordx4 v10, s[52:55], s14 offen nt lds
    s_add_u32 s14, s14, 9216
    s_add_u32 s15, s15, 1024
    s_mov_b32 s72, s14
    s_mov_b32 s73, s15
    s_mov_b32 s15, 0x3fb8aa3b
    s_branch L_kp
L_ml:
Lfw_3:
    ds_read_b32 v4, v2 offset:8
    s_waitcnt lgkmcnt(0)
    v_readfirstlane_b32 s11, v4
    s_nop 0
    s_cmp_ge_u32 s11, 4
    s_cbranch_scc1 Lfd_4
    s_sleep 1
    s_sub_u32 s42, s42, 1
    s_cbranch_scc0 Lfw_3
    s_branch L_abort
Lfd_4:
    v_and_b32 v9, 3, v1
    v_lshlrev_b32 v9, 4, v9
    ds_read_b128 v[232:235], v9 offset:768
    s_lshl_b32 s14, s2, 7
    s_add_u32 s14, s14, 1048576
    s_xor_b32 s12, s14, 16384
    s_waitcnt lgkmcnt(0)
    v_mov_b32 v236, v232
    v_mov_b32 v238, v234
    s_nop 0
    v_max_f32_dpp v236, v236, v236 quad_perm:[1,0,3,2] row_mask:0xf bank_mask:0xf
    v_max_f32_dpp v238, v238, v238 quad_perm:[1,0,3,2] row_mask:0xf bank_mask:0xf
    s_nop 0
    v_max_f32_dpp v236, v236, v236 quad_perm:[2,3,0,1] row_mask:0xf bank_mask:0xf
    v_max_f32_dpp v238, v238, v238 quad_perm:[2,3,0,1] row_mask:0xf bank_mask:0xf
    v_sub_f32 v232, v232, v236
    v_sub_f32 v234, v234, v238
    v_mul_f32 v232, s15, v232
    v_mul_f32 v234, s15, v234
    v_exp_f32 v232, v232
    v_exp_f32 v234, v234
    v_mul_f32 v237, v232, v233
    v_mul_f32 v239, v234, v235
    s_nop 0
    v_add_f32_dpp v237, v237, v237 quad_perm:[1,0,3,2] row_mask:0xf bank_mask:0xf
    v_add_f32_dpp v239, v239, v239 quad_perm:[1,0,3,2] row_mask:0xf bank_mask:0xf
    s_nop 0
    v_add_f32_dpp v237, v237, v237 quad_perm:[2,3,0,1] row_mask:0xf bank_mask:0xf
    v_add_f32_dpp v239, v239, v239 quad_perm:[2,3,0,1] row_mask:0xf bank_mask:0xf
    v_readfirstlane_b32 s56, v236
    s_mov_b32 s57, s26
    v_readfirstlane_b32 s58, v237
    s_mov_b32 s59, s27
    v_readfirstlane_b32 s60, v238
    s_mov_b32 s61, s26
    v_readfirstlane_b32 s62, v239
    s_mov_b32 s63, s27
    s_atomic_swap_x2 s[56:57], s[40:41], s14 offset:0
    s_atomic_swap_x2 s[58:59], s[40:41], s14 offset:8
    s_atomic_swap_x2 s[60:61], s[40:41], s14 offset:16
    s_atomic_swap_x2 s[62:63], s[40:41], s14 offset:24
L_mlp:
    s_load_dwordx8 s[68:75], s[40:41], s12 glc
    s_waitcnt lgkmcnt(0)
    s_xor_b32 s11, s69, s26
    s_xor_b32 s14, s71, s27
    s_or_b32 s11, s11, s14
    s_xor_b32 s14, s73, s26
    s_or_b32 s11, s11, s14
    s_xor_b32 s14, s75, s27
    s_or_b32 s11, s11, s14
    s_cbranch_scc0 L_mld
    s_sleep 2
    s_sub_u32 s42, s42, 1
    s_cbranch_scc0 L_mlp
    s_branch L_abort
L_mld:
    v_max_f32 v240, s68, v236
    v_max_f32 v242, s72, v238
    v_sub_f32 v236, v236, v240
    v_sub_f32 v238, v238, v242
    v_sub_f32 v232, s68, v240
    v_sub_f32 v234, s72, v242
    v_mul_f32 v236, s15, v236
    v_mul_f32 v238, s15, v238
    v_mul_f32 v232, s15, v232
    v_mul_f32 v234, s15, v234
    v_exp_f32 v236, v236
    v_exp_f32 v238, v238
    v_exp_f32 v232, v232
    v_exp_f32 v234, v234
    v_mul_f32 v237, v236, v237
    v_mul_f32 v239, v238, v239
    v_fma_f32 v237, v232, s70, v237
    v_fma_f32 v239, v234, s74, v239
    v_rcp_f32 v241, v237
    v_rcp_f32 v243, v239
    v_mul_f32 v240, s15, v240
    v_mul_f32 v242, s15, v242
    s_mov_b64 exec, 1
    ds_write_b128 v2, v[240:243] offset:896
    ds_add_u32 v2, v3 offset:4
    s_mov_b64 exec, -1
L_kp:
Lfw_5:
    ds_read_b32 v4, v2 offset:4
    s_waitcnt lgkmcnt(0)
    v_readfirstlane_b32 s11, v4
    s_nop 0
    s_cmp_ge_u32 s11, 1
    s_cbranch_scc1 Lfd_6
    s_sleep 1
    s_sub_u32 s42, s42, 1
    s_cbranch_scc0 Lfw_5
    s_branch L_abort
Lfd_6:
    ds_read_b64 v[14:15], v8 offset:896
    s_waitcnt lgkmcnt(0)
    v_fma_f32 v160, v160, s15, -v14
    v_fma_f32 v161, v161, s15, -v14
    v_fma_f32 v162, v162, s15, -v14
    v_fma_f32 v163, v163, s15, -v14
    v_exp_f32 v160, v160
    v_exp_f32 v161, v161
    v_exp_f32 v162, v162
    v_exp_f32 v163, v163
    v_mul_f32 v160, v160, v15
    v_mul_f32 v161, v161, v15
    v_mul_f32 v162, v162, v15
    v_mul_f32 v163, v163, v15
    v_cvt_pk_bf16_f32 v160, v160, v160
    v_cvt_pk_bf16_f32 v161, v161, v161
    v_cvt_pk_bf16_f32 v162, v162, v162
    v_cvt_pk_bf16_f32 v163, v163, v163
    ds_write_b32 v16, v160 offset:8192
    ds_write_b32 v16, v161 offset:8224
    ds_write_b32 v16, v162 offset:8256
    ds_write_b32 v16, v163 offset:8288
    s_mov_b64 exec, 1
    ds_add_u32 v2, v3 offset:40
    s_mov_b64 exec, -1
    s_cmp_lg_u32 s3, 4
    s_cbranch_scc1 L_arr_d
    v_and_b32 v11, 31, v1
    v_lshlrev_b32 v11, 7, v11
    s_lshl_b32 s57, s4, 12
    s_add_u32 s57, s57, 2490368
    s_getreg_b32 s58, hwreg(HW_REG_XCC_ID)
    s_and_b32 s58, s58, 7
L_arr_p:
    s_cmp_lg_u32 s43, 0
    s_cbranch_scc1 L_arr_d
    buffer_load_dwordx4 v[216:219], v11, s[44:47], s57 offen sc1
    s_waitcnt vmcnt(0)
    v_cmp_ne_u64 vcc, s[26:27], v[218:219]
    s_cbranch_vccnz L_q_ae3
    v_cmp_ne_u32 vcc, s58, v216
    s_nop 0
    s_cmp_eq_u64 vcc, 0
    s_cselect_b32 s43, 1, 2
    v_mov_b32 v4, s43
    ds_write_b32 v2, v4 offset:32
L_q_ae3:
    s_sub_u32 s42, s42, 1
    s_cbranch_scc0 L_arr_p
    s_branch L_abort
L_arr_d:
    s_setprio 0
    s_branch L_roles
L_vw:
    s_mov_b32 s44, s40
    s_and_b32 s45, s41, 0xffff
    s_mov_b32 s46, 536870912
    s_mov_b32 s47, 0x20000
    s_setprio 3
    s_cmp_lg_u32 s3, 7
    s_cbranch_scc1 L_pz_done
    v_mov_b32 v200, -1
    v_mov_b32 v201, -1
    v_mov_b32 v202, -1
    v_mov_b32 v203, -1
    s_lshl_b32 s15, s2, 10
    s_add_u32 s15, s15, 2621440
    buffer_store_dwordx4 v[200:203], v6, s[44:47], s15 offen sc1
    v_lshrrev_b32 v11, 3, v1
    v_and_b32 v12, 7, v1
    v_mul_u32_u24 v14, 2304, v11
    v_lshl_add_u32 v14, v12, 4, v14
    s_cmp_lt_u32 s5, 18
    s_cbranch_scc1 L_pz_ffn
    s_cmp_lt_u32 s5, 27
    s_cbranch_scc1 L_pz_wo
    s_cmp_lt_u32 s5, 31
    s_cbranch_scc1 L_pz_rr
    s_branch L_pz_done
L_pz_ffn:
    s_cmp_ge_u32 s5, 9
    s_cselect_b32 s14, 9, 0
    s_cselect_b32 s11, 9216, 0
    s_sub_u32 s14, s5, s14
    s_lshl_b32 s14, s14, 10
    s_add_u32 s14, s14, s11
    s_add_u32 s14, s14, s13
    s_add_u32 s14, s14, 1835008
    buffer_store_dwordx4 v[200:203], v6, s[44:47], s14 offen sc1
    s_branch L_pz_done
L_pz_wo:
    s_sub_u32 s14, s5, 18
    s_lshl_b32 s14, s14, 8
    s_mul_i32 s11, s4, 18432
    s_add_u32 s14, s14, s11
    s_add_u32 s11, s14, 2097152
    s_add_u32 s14, s14, 1310720
    buffer_store_dwordx4 v[200:203], v14, s[44:47], s14 offen offset:0 sc1
    buffer_store_dwordx4 v[200:203], v14, s[44:47], s14 offen offset:128 sc1
    buffer_store_dwordx4 v[200:203], v14, s[44:47], s11 offen offset:0 sc1
    buffer_store_dwordx4 v[200:203], v14, s[44:47], s11 offen offset:128 sc1
    s_branch L_pz_done
L_pz_rr:
    s_sub_u32 s14, s5, 27
    s_lshl_b32 s11, s14, 5
    s_mul_i32 s14, s14, 2304
    s_add_u32 s15, s13, 1572864
    s_add_u32 s14, s14, s15
    s_add_u32 s11, s11, s15
    s_add_u32 s15, s14, 9216
    s_mov_b32 exec_hi, 0xffff
    buffer_store_dwordx4 v[200:203], v6, s[44:47], s14 offen offset:0 sc1
    buffer_store_dwordx4 v[200:203], v6, s[44:47], s14 offen offset:768 sc1
    buffer_store_dwordx4 v[200:203], v6, s[44:47], s14 offen offset:1536 sc1
    buffer_store_dwordx4 v[200:203], v6, s[44:47], s15 offen offset:0 sc1
    buffer_store_dwordx4 v[200:203], v6, s[44:47], s15 offen offset:768 sc1
    buffer_store_dwordx4 v[200:203], v6, s[44:47], s15 offen offset:1536 sc1
    s_mov_b64 exec, 3
    s_add_u32 s11, s11, 18432
    buffer_store_dwordx4 v[200:203], v6, s[44:47], s11 offen sc1
    s_mov_b64 exec, -1
L_pz_done:
    s_sub_u32 s11, s5, 18
    s_cmp_lt_u32 s11, 9
    s_cbranch_scc1 L_vw_np
    s_sub_u32 s12, s5, 9
    s_cmp_lt_u32 s5, 18
    s_cselect_b32 s12, s5, s12
    s_mul_i32 s63, s12, 37
    s_lshr_b32 s63, s63, 8
    s_mul_i32 s62, s63, 7
    s_sub_u32 s62, s12, s62
    s_sub_u32 s61, s5, 30
    s_cmp_ge_u32 s5, 30
    s_cselect_b32 s63, s61, s63
    s_cselect_b32 s62, 7, s62
    s_mul_i32 s61, s63, 192
    s_cmp_eq_u32 s5, 31
    s_cselect_b32 s61, 288, s61
    s_mov_b32 s56, s22
    s_and_b32 s57, s23, 0xffff
    s_mov_b32 s58, 4718592
    s_mov_b32 s59, 0x20000
    v_lshrrev_b32 v11, 3, v1
    s_mov_b32 s11, 8192
    v_mul_lo_u32 v9, v11, s11
    v_and_b32 v11, 2, v11
    v_and_b32 v12, 7, v1
    v_xor_b32 v12, v12, v11
    v_xor_b32 v11, 4, v12
    v_lshl_add_u32 v10, v11, 4, v9
    v_lshl_add_u32 v9, v12, 4, v9
    s_sub_u32 s12, s3, 5
    s_lshl_b32 s14, s61, 13
    s_lshl_b32 s15, s4, 10
    s_add_u32 s14, s14, s15
    s_lshl_b32 s15, s62, 7
    s_add_u32 s14, s14, s15
    s_lshl_b32 s15, s12, 17
    s_add_u32 s14, s14, s15
    s_lshl_b32 s15, s12, 11
    s_add_u32 s15, s15, 24576
    v_add_u32 v10, 64512, v10
    s_mov_b32 m0, s15
    s_nop 0
    buffer_load_dwordx4 v9, s[56:59], s14 offen nt lds
    buffer_load_dwordx4 v10, s[56:59], s14 offen offset:1024 nt lds
    s_add_u32 s14, s14, 393216
    s_add_u32 s15, s15, 6144
    s_mov_b32 m0, s15
    s_nop 0
    buffer_load_dwordx4 v9, s[56:59], s14 offen nt lds
    buffer_load_dwordx4 v10, s[56:59], s14 offen offset:1024 nt lds
    s_add_u32 s14, s14, 393216
    s_add_u32 s15, s15, 6144
    s_mov_b32 m0, s15
    s_nop 0
    buffer_load_dwordx4 v9, s[56:59], s14 offen nt lds
    buffer_load_dwordx4 v10, s[56:59], s14 offen offset:1024 nt lds
    s_add_u32 s14, s14, 393216
    s_add_u32 s15, s15, 6144
    s_mov_b32 m0, s15
    s_nop 0
    buffer_load_dwordx4 v9, s[56:59], s14 offen nt lds
    buffer_load_dwordx4 v10, s[56:59], s14 offen offset:1024 nt lds
    s_add_u32 s14, s14, 393216
    s_add_u32 s15, s15, 6144
    s_cmp_lg_u32 s62, 7
    s_cbranch_scc1 L_vw_np
    s_mov_b32 m0, s15
    s_nop 0
    buffer_load_dwordx4 v9, s[56:59], s14 offen nt lds
    buffer_load_dwordx4 v10, s[56:59], s14 offen offset:1024 nt lds
    s_add_u32 s14, s14, 393216
    s_add_u32 s15, s15, 6144
    s_mov_b32 m0, s15
    s_nop 0
    buffer_load_dwordx4 v9, s[56:59], s14 offen nt lds
    buffer_load_dwordx4 v10, s[56:59], s14 offen offset:1024 nt lds
    s_add_u32 s14, s14, 393216
    s_add_u32 s15, s15, 6144
L_vw_np:
    s_mov_b32 s11, 2359296
    s_load_dwordx2 s[26:27], s[40:41], s11
    s_barrier
    s_cmp_lg_u32 s3, 7
    s_cbranch_scc1 L_vw_w
    s_getreg_b32 s14, hwreg(HW_REG_XCC_ID)
    s_and_b32 s14, s14, 7
    s_waitcnt lgkmcnt(0)
    s_add_u32 s60, s26, 0x9e3779b9
    s_addc_u32 s61, s27, 0x7f4a7c15
    v_mov_b32 v8, s14
    v_mov_b32 v9, 0
    v_mov_b32 v10, s60
    v_mov_b32 v11, s61
    s_lshl_b32 s11, s4, 5
    s_add_u32 s11, s11, s5
    s_lshl_b32 s11, s11, 7
    s_add_u32 s11, s11, 2490368
    s_waitcnt vmcnt(0)
    s_mov_b64 exec, 1
    ds_add_u32 v2, v3 offset:56
    buffer_store_dwordx4 v[8:11], v2, s[44:47], s11 offen sc1
    s_mov_b64 exec, -1
    s_branch L_vw_g
L_vw_w:
    s_waitcnt vmcnt(0)
    s_mov_b64 exec, 1
    ds_add_u32 v2, v3 offset:56
    s_mov_b64 exec, -1
L_vw_g:
    s_setprio 0
    s_sub_u32 s12, s3, 4
L_v:
    s_mov_b32 s52, s20
    s_and_b32 s53, s21, 0xffff
    s_mov_b32 s54, 134217728
    s_mov_b32 s55, 0x20000
    s_lshl_b32 s11, s12, 10
    s_add_u32 s68, s10, s11
    v_and_b32 v9, 1, v1
    v_cmp_eq_u32 vcc, 1, v9
    v_mov_b32 v10, 0xffff
    v_mov_b32 v11, s76
    v_cndmask_b32 v10, v10, v11, vcc
    v_bfe_u32 v9, v1, 1, 2
    v_cmp_eq_u32 vcc, 0, v9
    s_nop 1
    v_cndmask_b32 v240, 0, v10, vcc
    v_cmp_eq_u32 vcc, 1, v9
    s_nop 1
    v_cndmask_b32 v241, 0, v10, vcc
    v_cmp_eq_u32 vcc, 2, v9
    s_nop 1
    v_cndmask_b32 v242, 0, v10, vcc
    v_cmp_eq_u32 vcc, 3, v9
    s_nop 1
    v_cndmask_b32 v243, 0, v10, vcc
    v_bfe_u32 v8, v1, 3, 1
    v_lshlrev_b32 v8, 11, v8
    v_lshrrev_b32 v9, 4, v1
    v_lshl_add_u32 v8, v9, 9, v8
    s_lshl_b32 s11, s12, 7
    v_add_u32 v8, s11, v8
    s_waitcnt vmcnt(0)
Lfw_7:
    ds_read_b32 v4, v2 offset:52
    s_waitcnt lgkmcnt(0)
    v_readfirstlane_b32 s11, v4
    s_nop 0
    s_cmp_ge_u32 s11, 4
    s_cbranch_scc1 Lfd_8
    s_sleep 2
    s_sub_u32 s42, s42, 1
    s_cbranch_scc0 Lfw_7
    s_branch L_abort
Lfd_8:
    buffer_load_dwordx4 v[16:19], v6, s[52:55], s68 offen nt
    s_add_u32 s68, s68, 4096
    buffer_load_dwordx4 v[20:23], v6, s[52:55], s68 offen nt
    s_add_u32 s68, s68, 4096
    buffer_load_dwordx4 v[24:27], v6, s[52:55], s68 offen nt
    s_add_u32 s68, s68, 4096
    buffer_load_dwordx4 v[28:31], v6, s[52:55], s68 offen nt
    s_add_u32 s68, s68, 4096
    buffer_load_dwordx4 v[32:35], v6, s[52:55], s68 offen nt
    s_add_u32 s68, s68, 4096
    buffer_load_dwordx4 v[36:39], v6, s[52:55], s68 offen nt
    s_add_u32 s68, s68, 4096
    buffer_load_dwordx4 v[40:43], v6, s[52:55], s68 offen nt
    s_add_u32 s68, s68, 4096
    buffer_load_dwordx4 v[44:47], v6, s[52:55], s68 offen nt
    s_add_u32 s68, s68, 4096
    buffer_load_dwordx4 v[48:51], v6, s[52:55], s68 offen nt
    s_add_u32 s68, s68, 4096
    buffer_load_dwordx4 v[52:55], v6, s[52:55], s68 offen nt
    s_add_u32 s68, s68, 4096
    buffer_load_dwordx4 v[56:59], v6, s[52:55], s68 offen nt
    s_add_u32 s68, s68, 4096
    buffer_load_dwordx4 v[60:63], v6, s[52:55], s68 offen nt
    s_add_u32 s68, s68, 4096
    buffer_load_dwordx4 v[64:67], v6, s[52:55], s68 offen nt
    s_add_u32 s68, s68, 4096
    buffer_load_dwordx4 v[68:71], v6, s[52:55], s68 offen nt
    s_add_u32 s68, s68, 4096
    buffer_load_dwordx4 v[72:75], v6, s[52:55], s68 offen nt
    s_add_u32 s68, s68, 4096
    buffer_load_dwordx4 v[76:79], v6, s[52:55], s68 offen nt
    s_add_u32 s68, s68, 4096
    buffer_load_dwordx4 v[80:83], v6, s[52:55], s68 offen nt
    s_add_u32 s68, s68, 4096
    buffer_load_dwordx4 v[84:87], v6, s[52:55], s68 offen nt
    s_add_u32 s68, s68, 4096
    buffer_load_dwordx4 v[88:91], v6, s[52:55], s68 offen nt
    s_add_u32 s68, s68, 4096
    buffer_load_dwordx4 v[92:95], v6, s[52:55], s68 offen nt
    s_add_u32 s68, s68, 4096
    buffer_load_dwordx4 v[96:99], v6, s[52:55], s68 offen nt
    s_add_u32 s68, s68, 4096
    buffer_load_dwordx4 v[100:103], v6, s[52:55], s68 offen nt
    s_add_u32 s68, s68, 4096
    buffer_load_dwordx4 v[104:107], v6, s[52:55], s68 offen nt
    s_add_u32 s68, s68, 4096
    buffer_load_dwordx4 v[108:111], v6, s[52:55], s68 offen nt
    s_add_u32 s68, s68, 4096
    buffer_load_dwordx4 v[112:115], v6, s[52:55], s68 offen nt
    s_add_u32 s68, s68, 4096
    buffer_load_dwordx4 v[116:119], v6, s[52:55], s68 offen nt
    s_add_u32 s68, s68, 4096
    buffer_load_dwordx4 v[120:123], v6, s[52:55], s68 offen nt
    s_add_u32 s68, s68, 4096
    buffer_load_dwordx4 v[124:127], v6, s[52:55], s68 offen nt
    s_add_u32 s68, s68, 4096
    buffer_load_dwordx4 v[128:131], v6, s[52:55], s68 offen nt
    s_add_u32 s68, s68, 4096
    buffer_load_dwordx4 v[132:135], v6, s[52:55], s68 offen nt
    s_add_u32 s68, s68, 4096
    buffer_load_dwordx4 v[136:139], v6, s[52:55], s68 offen nt
    s_add_u32 s68, s68, 4096
    buffer_load_dwordx4 v[140:143], v6, s[52:55], s68 offen nt
    s_add_u32 s68, s68, 4096
L_vdone:
    s_cmp_lg_u32 s3, 0
    s_cbranch_scc1 L_gpe
Lfw_9:
    ds_read_b32 v4, v2 offset:32
    s_waitcnt lgkmcnt(0)
    v_readfirstlane_b32 s43, v4
    s_nop 0
    s_cmp_ge_u32 s43, 1
    s_cbranch_scc1 Lfd_10
    s_sleep 2
    s_sub_u32 s42, s42, 1
    s_cbranch_scc0 Lfw_9
    s_branch L_abort
Lfd_10:
    s_cmp_eq_u32 s43, 1
    s_cbranch_scc1 L_gpe
    s_cmp_eq_u32 s63, 0
    s_cbranch_scc1 L_gpe
    s_add_u32 s11, s77, 3145728
    buffer_store_dwordx4 v[224:227], v13, s[44:47], s11 offen offset:0 sc1
    buffer_store_dwordx4 v[228:231], v13, s[44:47], s11 offen offset:128 sc1
    buffer_store_dwordx4 v[232:235], v13, s[44:47], s11 offen offset:256 sc1
    buffer_store_dwordx4 v[236:239], v13, s[44:47], s11 offen offset:384 sc1
    s_cmp_lg_u32 s62, 7
    s_cbranch_scc1 L_gpe
    v_mov_b32 v220, 0
    v_mov_b32 v221, 0
    v_mov_b32 v222, s26
    v_mov_b32 v223, s27
    buffer_store_dwordx4 v[220:223], v13, s[44:47], s74 offen offset:0 sc1
    buffer_store_dwordx4 v[220:223], v13, s[44:47], s74 offen offset:128 sc1
    buffer_store_dwordx4 v[220:223], v13, s[44:47], s74 offen offset:256 sc1
    buffer_store_dwordx4 v[220:223], v13, s[44:47], s74 offen offset:384 sc1
L_gpe:
    s_setprio 2
Lfw_11:
    ds_read_b32 v4, v2 offset:40
    s_waitcnt lgkmcnt(0)
    v_readfirstlane_b32 s11, v4
    s_nop 0
    s_cmp_ge_u32 s11, 4
    s_cbranch_scc1 Lfd_12
    s_sleep 1
    s_sub_u32 s42, s42, 1
    s_cbranch_scc0 Lfw_11
    s_branch L_abort
Lfd_12:
    ds_read_b128 v[144:147], v8 offset:8192
    ds_read_b128 v[148:151], v8 offset:8208
    ds_read_b128 v[152:155], v8 offset:8224
    ds_read_b128 v[156:159], v8 offset:8240
    ds_read_b128 v[160:163], v8 offset:8256
    ds_read_b128 v[164:167], v8 offset:8272
    ds_read_b128 v[168:171], v8 offset:8288
    ds_read_b128 v[172:175], v8 offset:8304
    s_waitcnt lgkmcnt(0)
    v_and_b32 v176, v144, v240
    v_and_b32 v177, v144, v241
    v_and_b32 v178, v144, v242
    v_and_b32 v179, v144, v243
    v_and_b32 v180, v145, v240
    v_and_b32 v181, v145, v241
    v_and_b32 v182, v145, v242
    v_and_b32 v183, v145, v243
    v_and_b32 v184, v146, v240
    v_and_b32 v185, v146, v241
    v_and_b32 v186, v146, v242
    v_and_b32 v187, v146, v243
    v_and_b32 v188, v147, v240
    v_and_b32 v189, v147, v241
    v_and_b32 v190, v147, v242
    v_and_b32 v191, v147, v243
    v_and_b32 v192, v148, v240
    v_and_b32 v193, v148, v241
    v_and_b32 v194, v148, v242
    v_and_b32 v195, v148, v243
    v_and_b32 v196, v149, v240
    v_and_b32 v197, v149, v241
    v_and_b32 v198, v149, v242
    v_and_b32 v199, v149, v243
    v_and_b32 v200, v150, v240
    v_and_b32 v201, v150, v241
    v_and_b32 v202, v150, v242
    v_and_b32 v203, v150, v243
    v_and_b32 v204, v151, v240
    v_and_b32 v205, v151, v241
    v_and_b32 v206, v151, v242
    v_and_b32 v207, v151, v243
    v_and_b32 v208, v152, v240
    v_and_b32 v209, v152, v241
    v_and_b32 v210, v152, v242
    v_and_b32 v211, v152, v243
    s_waitcnt vmcnt(31)
    v_mfma_f32_16x16x32_bf16 v[244:247], v[16:19], v[176:179], 0
    v_and_b32 v212, v153, v240
    v_and_b32 v213, v153, v241
    v_and_b32 v214, v153, v242
    v_and_b32 v215, v153, v243
    s_waitcnt vmcnt(30)
    v_mfma_f32_16x16x32_bf16 v[244:247], v[20:23], v[180:183], v[244:247]
    v_and_b32 v216, v154, v240
    v_and_b32 v217, v154, v241
    v_and_b32 v218, v154, v242
    v_and_b32 v219, v154, v243
    s_waitcnt vmcnt(29)
    v_mfma_f32_16x16x32_bf16 v[244:247], v[24:27], v[184:187], v[244:247]
    v_and_b32 v220, v155, v240
    v_and_b32 v221, v155, v241
    v_and_b32 v222, v155, v242
    v_and_b32 v223, v155, v243
    s_waitcnt vmcnt(28)
    v_mfma_f32_16x16x32_bf16 v[244:247], v[28:31], v[188:191], v[244:247]
    v_and_b32 v224, v156, v240
    v_and_b32 v225, v156, v241
    v_and_b32 v226, v156, v242
    v_and_b32 v227, v156, v243
    s_waitcnt vmcnt(27)
    v_mfma_f32_16x16x32_bf16 v[244:247], v[32:35], v[192:195], v[244:247]
    v_and_b32 v228, v157, v240
    v_and_b32 v229, v157, v241
    v_and_b32 v230, v157, v242
    v_and_b32 v231, v157, v243
    s_waitcnt vmcnt(26)
    v_mfma_f32_16x16x32_bf16 v[244:247], v[36:39], v[196:199], v[244:247]
    v_and_b32 v232, v158, v240
    v_and_b32 v233, v158, v241
    v_and_b32 v234, v158, v242
    v_and_b32 v235, v158, v243
    s_waitcnt vmcnt(25)
    v_mfma_f32_16x16x32_bf16 v[244:247], v[40:43], v[200:203], v[244:247]
    v_and_b32 v236, v159, v240
    v_and_b32 v237, v159, v241
    v_and_b32 v238, v159, v242
    v_and_b32 v239, v159, v243
    s_waitcnt vmcnt(24)
    v_mfma_f32_16x16x32_bf16 v[244:247], v[44:47], v[204:207], v[244:247]
    v_and_b32 v176, v160, v240
    v_and_b32 v177, v160, v241
    v_and_b32 v178, v160, v242
    v_and_b32 v179, v160, v243
    s_waitcnt vmcnt(23)
    v_mfma_f32_16x16x32_bf16 v[244:247], v[48:51], v[208:211], v[244:247]
    v_and_b32 v180, v161, v240
    v_and_b32 v181, v161, v241
    v_and_b32 v182, v161, v242
    v_and_b32 v183, v161, v243
    s_waitcnt vmcnt(22)
    v_mfma_f32_16x16x32_bf16 v[244:247], v[52:55], v[212:215], v[244:247]
    v_and_b32 v184, v162, v240
    v_and_b32 v185, v162, v241
    v_and_b32 v186, v162, v242
    v_and_b32 v187, v162, v243
    s_waitcnt vmcnt(21)
    v_mfma_f32_16x16x32_bf16 v[244:247], v[56:59], v[216:219], v[244:247]
    v_and_b32 v188, v163, v240
    v_and_b32 v189, v163, v241
    v_and_b32 v190, v163, v242
    v_and_b32 v191, v163, v243
    s_waitcnt vmcnt(20)
    v_mfma_f32_16x16x32_bf16 v[244:247], v[60:63], v[220:223], v[244:247]
    v_and_b32 v192, v164, v240
    v_and_b32 v193, v164, v241
    v_and_b32 v194, v164, v242
    v_and_b32 v195, v164, v243
    s_waitcnt vmcnt(19)
    v_mfma_f32_16x16x32_bf16 v[244:247], v[64:67], v[224:227], v[244:247]
    v_and_b32 v196, v165, v240
    v_and_b32 v197, v165, v241
    v_and_b32 v198, v165, v242
    v_and_b32 v199, v165, v243
    s_waitcnt vmcnt(18)
    v_mfma_f32_16x16x32_bf16 v[244:247], v[68:71], v[228:231], v[244:247]
    v_and_b32 v200, v166, v240
    v_and_b32 v201, v166, v241
    v_and_b32 v202, v166, v242
    v_and_b32 v203, v166, v243
    s_waitcnt vmcnt(17)
    v_mfma_f32_16x16x32_bf16 v[244:247], v[72:75], v[232:235], v[244:247]
    v_and_b32 v204, v167, v240
    v_and_b32 v205, v167, v241
    v_and_b32 v206, v167, v242
    v_and_b32 v207, v167, v243
    s_waitcnt vmcnt(16)
    v_mfma_f32_16x16x32_bf16 v[244:247], v[76:79], v[236:239], v[244:247]
    v_and_b32 v208, v168, v240
    v_and_b32 v209, v168, v241
    v_and_b32 v210, v168, v242
    v_and_b32 v211, v168, v243
    s_waitcnt vmcnt(15)
    v_mfma_f32_16x16x32_bf16 v[244:247], v[80:83], v[176:179], v[244:247]
    v_and_b32 v212, v169, v240
    v_and_b32 v213, v169, v241
    v_and_b32 v214, v169, v242
    v_and_b32 v215, v169, v243
    s_waitcnt vmcnt(14)
    v_mfma_f32_16x16x32_bf16 v[244:247], v[84:87], v[180:183], v[244:247]
    v_and_b32 v216, v170, v240
    v_and_b32 v217, v170, v241
    v_and_b32 v218, v170, v242
    v_and_b32 v219, v170, v243
    s_waitcnt vmcnt(13)
    v_mfma_f32_16x16x32_bf16 v[244:247], v[88:91], v[184:187], v[244:247]
    v_and_b32 v220, v171, v240
    v_and_b32 v221, v171, v241
    v_and_b32 v222, v171, v242
    v_and_b32 v223, v171, v243
    s_waitcnt vmcnt(12)
    v_mfma_f32_16x16x32_bf16 v[244:247], v[92:95], v[188:191], v[244:247]
    v_and_b32 v224, v172, v240
    v_and_b32 v225, v172, v241
    v_and_b32 v226, v172, v242
    v_and_b32 v227, v172, v243
    s_waitcnt vmcnt(11)
    v_mfma_f32_16x16x32_bf16 v[244:247], v[96:99], v[192:195], v[244:247]
    v_and_b32 v228, v173, v240
    v_and_b32 v229, v173, v241
    v_and_b32 v230, v173, v242
    v_and_b32 v231, v173, v243
    s_waitcnt vmcnt(10)
    v_mfma_f32_16x16x32_bf16 v[244:247], v[100:103], v[196:199], v[244:247]
    v_and_b32 v232, v174, v240
    v_and_b32 v233, v174, v241
    v_and_b32 v234, v174, v242
    v_and_b32 v235, v174, v243
    s_waitcnt vmcnt(9)
    v_mfma_f32_16x16x32_bf16 v[244:247], v[104:107], v[200:203], v[244:247]
    v_and_b32 v236, v175, v240
    v_and_b32 v237, v175, v241
    v_and_b32 v238, v175, v242
    v_and_b32 v239, v175, v243
    s_waitcnt vmcnt(8)
    v_mfma_f32_16x16x32_bf16 v[244:247], v[108:111], v[204:207], v[244:247]
    s_waitcnt vmcnt(7)
    v_mfma_f32_16x16x32_bf16 v[244:247], v[112:115], v[208:211], v[244:247]
    s_waitcnt vmcnt(6)
    v_mfma_f32_16x16x32_bf16 v[244:247], v[116:119], v[212:215], v[244:247]
    s_waitcnt vmcnt(5)
    v_mfma_f32_16x16x32_bf16 v[244:247], v[120:123], v[216:219], v[244:247]
    s_waitcnt vmcnt(4)
    v_mfma_f32_16x16x32_bf16 v[244:247], v[124:127], v[220:223], v[244:247]
    s_waitcnt vmcnt(3)
    v_mfma_f32_16x16x32_bf16 v[244:247], v[128:131], v[224:227], v[244:247]
    s_waitcnt vmcnt(2)
    v_mfma_f32_16x16x32_bf16 v[244:247], v[132:135], v[228:231], v[244:247]
    s_waitcnt vmcnt(1)
    v_mfma_f32_16x16x32_bf16 v[244:247], v[136:139], v[232:235], v[244:247]
    s_waitcnt vmcnt(0)
    v_mfma_f32_16x16x32_bf16 v[244:247], v[140:143], v[236:239], v[244:247]
    s_lshl_b32 s11, s12, 10
    v_add_u32 v8, s11, v6
    s_lshl_b32 s14, s2, 10
    s_add_u32 s14, s14, 2621440
    s_nop 3
    ds_write_b128 v8, v[244:247] offset:4096
    s_mov_b64 exec, 1
    ds_add_rtn_u32 v7, v2, v3 offset:12
    s_mov_b64 exec, -1
Lfw_13:
    ds_read_b32 v4, v2 offset:32
    s_waitcnt lgkmcnt(0)
    v_readfirstlane_b32 s43, v4
    s_nop 0
    s_cmp_ge_u32 s43, 1
    s_cbranch_scc1 Lfd_14
    s_sleep 1
    s_sub_u32 s42, s42, 1
    s_cbranch_scc0 Lfw_13
    s_branch L_abort
Lfd_14:
    v_readfirstlane_b32 s11, v7
    s_nop 0
    s_cmp_lg_u32 s11, 3
    s_cbranch_scc1 L_roles
    ds_read_b128 v[200:203], v6 offset:4096
    ds_read_b128 v[204:207], v6 offset:5120
    ds_read_b128 v[208:211], v6 offset:6144
    ds_read_b128 v[212:215], v6 offset:7168
    s_waitcnt lgkmcnt(0)
    v_pk_add_f32 v[200:201], v[200:201], v[204:205]
    v_pk_add_f32 v[202:203], v[202:203], v[206:207]
    v_pk_add_f32 v[208:209], v[208:209], v[212:213]
    v_pk_add_f32 v[210:211], v[210:211], v[214:215]
    v_pk_add_f32 v[200:201], v[200:201], v[208:209]
    v_pk_add_f32 v[202:203], v[202:203], v[210:211]
    v_min_u32 v200, -2, v200
    v_min_u32 v201, -2, v201
    v_min_u32 v202, -2, v202
    v_min_u32 v203, -2, v203
    s_cmp_eq_u32 s43, 1
    s_cbranch_scc0 Lps_15
    buffer_store_dwordx4 v[200:203], v6, s[44:47], s14 offen offset:0
    s_branch Lpe_16
Lps_15:
    buffer_store_dwordx4 v[200:203], v6, s[44:47], s14 offen offset:0 sc1
Lpe_16:
    s_mov_b64 exec, 1
    ds_add_u32 v2, v3 offset:12
    s_mov_b64 exec, -1
    s_branch L_roles
L_w0:
    s_setprio 3
    s_mov_b32 s11, 2359296
    s_load_dwordx2 s[26:27], s[40:41], s11
    v_lshlrev_b32 v7, 2, v1
    s_mov_b32 s44, s40
    s_and_b32 s45, s41, 0xffff
    s_mov_b32 s46, 536870912
    s_mov_b32 s47, 0x20000
    s_sub_u32 s11, s5, 18
    s_cmp_lt_u32 s11, 9
    s_cbranch_scc1 L_w0_np
    s_mov_b32 s64, s16
    s_and_b32 s65, s17, 0xffff
    s_mov_b32 s66, 9216
    s_mov_b32 s67, 0x20000
    v_lshrrev_b32 v8, 3, v1
    v_mul_u32_u24 v8, 1152, v8
    v_and_b32 v11, 7, v1
    v_lshl_add_u32 v8, v11, 4, v8
    buffer_load_dwordx4 v[80:83], v8, s[64:67], 0 offen offset:0
    buffer_load_dwordx4 v[84:87], v8, s[64:67], 0 offen offset:128
    buffer_load_dwordx4 v[88:91], v8, s[64:67], 0 offen offset:256
    buffer_load_dwordx4 v[92:95], v8, s[64:67], 0 offen offset:384
    buffer_load_dwordx4 v[96:99], v8, s[64:67], 0 offen offset:512
    buffer_load_dwordx4 v[100:103], v8, s[64:67], 0 offen offset:640
    buffer_load_dwordx4 v[104:107], v8, s[64:67], 0 offen offset:768
    buffer_load_dwordx4 v[108:111], v8, s[64:67], 0 offen offset:896
    buffer_load_dwordx4 v[112:115], v8, s[64:67], 0 offen offset:1024
    s_sub_u32 s12, s5, 9
    s_cmp_lt_u32 s5, 18
    s_cselect_b32 s12, s5, s12
    s_mul_i32 s63, s12, 37
    s_lshr_b32 s63, s63, 8
    s_mul_i32 s62, s63, 7
    s_sub_u32 s62, s12, s62
    s_sub_u32 s61, s5, 30
    s_cmp_ge_u32 s5, 30
    s_cselect_b32 s63, s61, s63
    s_cselect_b32 s62, 7, s62
    s_mul_i32 s61, s63, 192
    s_cmp_eq_u32 s5, 31
    s_cselect_b32 s61, 288, s61
    s_lshl_b32 s14, s61, 1
    buffer_load_dwordx4 v[116:119], v8, s[64:67], s14 offen offset:0
    buffer_load_dwordx4 v[120:123], v8, s[64:67], s14 offen offset:128
    buffer_load_dwordx4 v[124:127], v8, s[64:67], s14 offen offset:256
    s_cmp_lg_u32 s62, 7
    s_cbranch_scc1 L_w0_nx
    buffer_load_dwordx4 v[184:187], v8, s[64:67], s14 offen offset:384
    buffer_load_dwordx4 v[188:191], v8, s[64:67], s14 offen offset:512
L_w0_nx:
    ds_write_b32 v7, v2
    s_waitcnt lgkmcnt(0)
    s_barrier
    v_lshrrev_b32 v11, 4, v1
    v_bfe_u32 v12, v1, 2, 2
    v_lshl_add_u32 v8, v11, 3, v12
    v_lshlrev_b32 v8, 7, v8
    v_and_b32 v11, 1, v11
    v_lshlrev_b32 v11, 6, v11
    v_and_b32 v12, 2, v12
    v_lshl_add_u32 v11, v12, 4, v11
    v_and_b32 v12, 3, v1
    v_lshlrev_b32 v12, 3, v12
    v_xor_b32 v11, v11, v12
    v_add_u32 v8, v8, v11
    v_add_u32 v8, 24576, v8
    v_and_b32 v10, 7, v1
    v_mul_u32_u24 v10, 640, v10
    v_lshrrev_b32 v11, 4, v1
    v_lshl_add_u32 v10, v11, 4, v10
    v_lshrrev_b32 v14, 3, v1
    v_mul_u32_u24 v14, 640, v14
    v_and_b32 v7, 7, v1
    v_lshl_add_u32 v14, v7, 4, v14
    v_and_b32 v13, 7, v1
    v_lshlrev_b32 v13, 12, v13
    v_lshl_add_u32 v13, v11, 5, v13
    v_bfe_u32 v7, v1, 3, 1
    v_lshl_add_u32 v13, v7, 4, v13
    s_lshl_b32 s77, s4, 2
    s_add_u32 s77, s77, s63
    s_lshl_b32 s77, s77, 15
    s_lshl_b32 s15, s62, 9
    s_add_u32 s77, s77, s15
    s_add_u32 s26, s26, 0x9e3779b9
    s_addc_u32 s27, s27, 0x7f4a7c15
    s_waitcnt vmcnt(11)
    v_lshlrev_b32 v128, 16, v80
    v_and_b32 v129, s76, v80
    v_pk_mul_f32 v[214:215], v[128:129], v[128:129]
    v_mov_b32 v212, v128
    v_mov_b32 v213, v129
    v_lshlrev_b32 v130, 16, v81
    v_and_b32 v131, s76, v81
    v_pk_mul_f32 v[218:219], v[130:131], v[130:131]
    v_mov_b32 v216, v130
    v_mov_b32 v217, v131
    v_lshlrev_b32 v132, 16, v82
    v_and_b32 v133, s76, v82
    v_pk_add_f32 v[212:213], v[212:213], v[132:133]
    v_pk_fma_f32 v[214:215], v[132:133], v[132:133], v[214:215]
    v_lshlrev_b32 v134, 16, v83
    v_and_b32 v135, s76, v83
    v_pk_add_f32 v[216:217], v[216:217], v[134:135]
    v_pk_fma_f32 v[218:219], v[134:135], v[134:135], v[218:219]
    s_waitcnt vmcnt(10)
    v_lshlrev_b32 v136, 16, v84
    v_and_b32 v137, s76, v84
    v_pk_add_f32 v[212:213], v[212:213], v[136:137]
    v_pk_fma_f32 v[214:215], v[136:137], v[136:137], v[214:215]
    v_lshlrev_b32 v138, 16, v85
    v_and_b32 v139, s76, v85
    v_pk_add_f32 v[216:217], v[216:217], v[138:139]
    v_pk_fma_f32 v[218:219], v[138:139], v[138:139], v[218:219]
    v_lshlrev_b32 v140, 16, v86
    v_and_b32 v141, s76, v86
    v_pk_add_f32 v[212:213], v[212:213], v[140:141]
    v_pk_fma_f32 v[214:215], v[140:141], v[140:141], v[214:215]
    v_lshlrev_b32 v142, 16, v87
    v_and_b32 v143, s76, v87
    v_pk_add_f32 v[216:217], v[216:217], v[142:143]
    v_pk_fma_f32 v[218:219], v[142:143], v[142:143], v[218:219]
    s_waitcnt vmcnt(9)
    v_lshlrev_b32 v128, 16, v88
    v_and_b32 v129, s76, v88
    v_pk_add_f32 v[212:213], v[212:213], v[128:129]
    v_pk_fma_f32 v[214:215], v[128:129], v[128:129], v[214:215]
    v_lshlrev_b32 v130, 16, v89
    v_and_b32 v131, s76, v89
    v_pk_add_f32 v[216:217], v[216:217], v[130:131]
    v_pk_fma_f32 v[218:219], v[130:131], v[130:131], v[218:219]
    v_lshlrev_b32 v132, 16, v90
    v_and_b32 v133, s76, v90
    v_pk_add_f32 v[212:213], v[212:213], v[132:133]
    v_pk_fma_f32 v[214:215], v[132:133], v[132:133], v[214:215]
    v_lshlrev_b32 v134, 16, v91
    v_and_b32 v135, s76, v91
    v_pk_add_f32 v[216:217], v[216:217], v[134:135]
    v_pk_fma_f32 v[218:219], v[134:135], v[134:135], v[218:219]
    s_waitcnt vmcnt(8)
    v_lshlrev_b32 v136, 16, v92
    v_and_b32 v137, s76, v92
    v_pk_add_f32 v[212:213], v[212:213], v[136:137]
    v_pk_fma_f32 v[214:215], v[136:137], v[136:137], v[214:215]
    v_lshlrev_b32 v138, 16, v93
    v_and_b32 v139, s76, v93
    v_pk_add_f32 v[216:217], v[216:217], v[138:139]
    v_pk_fma_f32 v[218:219], v[138:139], v[138:139], v[218:219]
    v_lshlrev_b32 v140, 16, v94
    v_and_b32 v141, s76, v94
    v_pk_add_f32 v[212:213], v[212:213], v[140:141]
    v_pk_fma_f32 v[214:215], v[140:141], v[140:141], v[214:215]
    v_lshlrev_b32 v142, 16, v95
    v_and_b32 v143, s76, v95
    v_pk_add_f32 v[216:217], v[216:217], v[142:143]
    v_pk_fma_f32 v[218:219], v[142:143], v[142:143], v[218:219]
    s_waitcnt vmcnt(7)
    v_lshlrev_b32 v128, 16, v96
    v_and_b32 v129, s76, v96
    v_pk_add_f32 v[212:213], v[212:213], v[128:129]
    v_pk_fma_f32 v[214:215], v[128:129], v[128:129], v[214:215]
    v_lshlrev_b32 v130, 16, v97
    v_and_b32 v131, s76, v97
    v_pk_add_f32 v[216:217], v[216:217], v[130:131]
    v_pk_fma_f32 v[218:219], v[130:131], v[130:131], v[218:219]
    v_lshlrev_b32 v132, 16, v98
    v_and_b32 v133, s76, v98
    v_pk_add_f32 v[212:213], v[212:213], v[132:133]
    v_pk_fma_f32 v[214:215], v[132:133], v[132:133], v[214:215]
    v_lshlrev_b32 v134, 16, v99
    v_and_b32 v135, s76, v99
    v_pk_add_f32 v[216:217], v[216:217], v[134:135]
    v_pk_fma_f32 v[218:219], v[134:135], v[134:135], v[218:219]
    s_waitcnt vmcnt(6)
    v_lshlrev_b32 v136, 16, v100
    v_and_b32 v137, s76, v100
    v_pk_add_f32 v[212:213], v[212:213], v[136:137]
    v_pk_fma_f32 v[214:215], v[136:137], v[136:137], v[214:215]
    v_lshlrev_b32 v138, 16, v101
    v_and_b32 v139, s76, v101
    v_pk_add_f32 v[216:217], v[216:217], v[138:139]
    v_pk_fma_f32 v[218:219], v[138:139], v[138:139], v[218:219]
    v_lshlrev_b32 v140, 16, v102
    v_and_b32 v141, s76, v102
    v_pk_add_f32 v[212:213], v[212:213], v[140:141]
    v_pk_fma_f32 v[214:215], v[140:141], v[140:141], v[214:215]
    v_lshlrev_b32 v142, 16, v103
    v_and_b32 v143, s76, v103
    v_pk_add_f32 v[216:217], v[216:217], v[142:143]
    v_pk_fma_f32 v[218:219], v[142:143], v[142:143], v[218:219]
    s_waitcnt vmcnt(5)
    v_lshlrev_b32 v128, 16, v104
    v_and_b32 v129, s76, v104
    v_pk_add_f32 v[212:213], v[212:213], v[128:129]
    v_pk_fma_f32 v[214:215], v[128:129], v[128:129], v[214:215]
    v_lshlrev_b32 v130, 16, v105
    v_and_b32 v131, s76, v105
    v_pk_add_f32 v[216:217], v[216:217], v[130:131]
    v_pk_fma_f32 v[218:219], v[130:131], v[130:131], v[218:219]
    v_lshlrev_b32 v132, 16, v106
    v_and_b32 v133, s76, v106
    v_pk_add_f32 v[212:213], v[212:213], v[132:133]
    v_pk_fma_f32 v[214:215], v[132:133], v[132:133], v[214:215]
    v_lshlrev_b32 v134, 16, v107
    v_and_b32 v135, s76, v107
    v_pk_add_f32 v[216:217], v[216:217], v[134:135]
    v_pk_fma_f32 v[218:219], v[134:135], v[134:135], v[218:219]
    s_waitcnt vmcnt(4)
    v_lshlrev_b32 v136, 16, v108
    v_and_b32 v137, s76, v108
    v_pk_add_f32 v[212:213], v[212:213], v[136:137]
    v_pk_fma_f32 v[214:215], v[136:137], v[136:137], v[214:215]
    v_lshlrev_b32 v138, 16, v109
    v_and_b32 v139, s76, v109
    v_pk_add_f32 v[216:217], v[216:217], v[138:139]
    v_pk_fma_f32 v[218:219], v[138:139], v[138:139], v[218:219]
    v_lshlrev_b32 v140, 16, v110
    v_and_b32 v141, s76, v110
    v_pk_add_f32 v[212:213], v[212:213], v[140:141]
    v_pk_fma_f32 v[214:215], v[140:141], v[140:141], v[214:215]
    v_lshlrev_b32 v142, 16, v111
    v_and_b32 v143, s76, v111
    v_pk_add_f32 v[216:217], v[216:217], v[142:143]
    v_pk_fma_f32 v[218:219], v[142:143], v[142:143], v[218:219]
    s_waitcnt vmcnt(3)
    v_lshlrev_b32 v128, 16, v112
    v_and_b32 v129, s76, v112
    v_pk_add_f32 v[212:213], v[212:213], v[128:129]
    v_pk_fma_f32 v[214:215], v[128:129], v[128:129], v[214:215]
    v_lshlrev_b32 v130, 16, v113
    v_and_b32 v131, s76, v113
    v_pk_add_f32 v[216:217], v[216:217], v[130:131]
    v_pk_fma_f32 v[218:219], v[130:131], v[130:131], v[218:219]
    v_lshlrev_b32 v132, 16, v114
    v_and_b32 v133, s76, v114
    v_pk_add_f32 v[212:213], v[212:213], v[132:133]
    v_pk_fma_f32 v[214:215], v[132:133], v[132:133], v[214:215]
    v_lshlrev_b32 v134, 16, v115
    v_and_b32 v135, s76, v115
    v_pk_add_f32 v[216:217], v[216:217], v[134:135]
    v_pk_fma_f32 v[218:219], v[134:135], v[134:135], v[218:219]
    v_pk_add_f32 v[212:213], v[212:213], v[216:217]
    v_pk_add_f32 v[214:215], v[214:215], v[218:219]
    v_add_f32 v200, v212, v213
    v_add_f32 v202, v214, v215
    s_waitcnt vmcnt(0)
    v_lshlrev_b32 v128, 16, v116
    v_and_b32 v129, s76, v116
    v_lshlrev_b32 v130, 16, v117
    v_and_b32 v131, s76, v117
    v_lshlrev_b32 v132, 16, v118
    v_and_b32 v133, s76, v118
    v_lshlrev_b32 v134, 16, v119
    v_and_b32 v135, s76, v119
    v_lshlrev_b32 v136, 16, v120
    v_and_b32 v137, s76, v120
    v_lshlrev_b32 v138, 16, v121
    v_and_b32 v139, s76, v121
    v_lshlrev_b32 v140, 16, v122
    v_and_b32 v141, s76, v122
    v_lshlrev_b32 v142, 16, v123
    v_and_b32 v143, s76, v123
    v_lshlrev_b32 v144, 16, v124
    v_and_b32 v145, s76, v124
    v_lshlrev_b32 v146, 16, v125
    v_and_b32 v147, s76, v125
    v_lshlrev_b32 v148, 16, v126
    v_and_b32 v149, s76, v126
    v_lshlrev_b32 v150, 16, v127
    v_and_b32 v151, s76, v127
    v_add_f32_dpp v200, v200, v200 quad_perm:[1,0,3,2] row_mask:0xf bank_mask:0xf
    v_add_f32_dpp v202, v202, v202 quad_perm:[1,0,3,2] row_mask:0xf bank_mask:0xf
    s_nop 0
    v_add_f32_dpp v200, v200, v200 quad_perm:[2,3,0,1] row_mask:0xf bank_mask:0xf
    v_add_f32_dpp v202, v202, v202 quad_perm:[2,3,0,1] row_mask:0xf bank_mask:0xf
    s_nop 0
    v_add_f32_dpp v200, v200, v200 row_half_mirror row_mask:0xf bank_mask:0xf
    v_add_f32_dpp v202, v202, v202 row_half_mirror row_mask:0xf bank_mask:0xf
    v_mul_f32 v211, 0xbae38e39, v200
    v_mul_f32 v210, 0x3ae38e39, v202
    v_fma_f32 v210, -v211, v211, v210
    v_max_f32 v210, 0, v210
    v_cvt_pk_bf16_f32 v210, v210, v211
    v_and_b32 v206, s76, v210
    v_lshlrev_b32 v210, 16, v210
    v_add_f32 v210, 0x3727c5ac, v210
    v_cvt_pk_bf16_f32 v210, v210, v210
    v_and_b32 v210, s76, v210
    v_sqrt_f32 v210, v210
    v_mov_b32 v207, v206
    v_cvt_pk_bf16_f32 v210, v210, v210
    v_and_b32 v210, s76, v210
    v_rcp_f32 v208, v210
    v_rcp_f32 v209, v210
    v_pk_add_f32 v[128:129], v[128:129], v[206:207]
    v_pk_add_f32 v[130:131], v[130:131], v[206:207]
    v_pk_add_f32 v[132:133], v[132:133], v[206:207]
    v_pk_add_f32 v[134:135], v[134:135], v[206:207]
    v_pk_add_f32 v[136:137], v[136:137], v[206:207]
    v_pk_add_f32 v[138:139], v[138:139], v[206:207]
    v_pk_add_f32 v[140:141], v[140:141], v[206:207]
    v_pk_add_f32 v[142:143], v[142:143], v[206:207]
    v_pk_add_f32 v[144:145], v[144:145], v[206:207]
    v_pk_add_f32 v[146:147], v[146:147], v[206:207]
    v_pk_add_f32 v[148:149], v[148:149], v[206:207]
    v_pk_add_f32 v[150:151], v[150:151], v[206:207]
    v_cvt_pk_bf16_f32 v116, v128, v129
    v_cvt_pk_bf16_f32 v117, v130, v131
    v_cvt_pk_bf16_f32 v118, v132, v133
    v_cvt_pk_bf16_f32 v119, v134, v135
    v_cvt_pk_bf16_f32 v120, v136, v137
    v_cvt_pk_bf16_f32 v121, v138, v139
    v_cvt_pk_bf16_f32 v122, v140, v141
    v_cvt_pk_bf16_f32 v123, v142, v143
    v_cvt_pk_bf16_f32 v124, v144, v145
    v_cvt_pk_bf16_f32 v125, v146, v147
    v_cvt_pk_bf16_f32 v126, v148, v149
    v_cvt_pk_bf16_f32 v127, v150, v151
    v_lshlrev_b32 v128, 16, v116
    v_and_b32 v129, s76, v116
    v_lshlrev_b32 v130, 16, v117
    v_and_b32 v131, s76, v117
    v_lshlrev_b32 v132, 16, v118
    v_and_b32 v133, s76, v118
    v_lshlrev_b32 v134, 16, v119
    v_and_b32 v135, s76, v119
    v_lshlrev_b32 v136, 16, v120
    v_and_b32 v137, s76, v120
    v_lshlrev_b32 v138, 16, v121
    v_and_b32 v139, s76, v121
    v_lshlrev_b32 v140, 16, v122
    v_and_b32 v141, s76, v122
    v_lshlrev_b32 v142, 16, v123
    v_and_b32 v143, s76, v123
    v_lshlrev_b32 v144, 16, v124
    v_and_b32 v145, s76, v124
    v_lshlrev_b32 v146, 16, v125
    v_and_b32 v147, s76, v125
    v_lshlrev_b32 v148, 16, v126
    v_and_b32 v149, s76, v126
    v_lshlrev_b32 v150, 16, v127
    v_and_b32 v151, s76, v127
    v_pk_mul_f32 v[128:129], v[128:129], v[208:209]
    v_pk_mul_f32 v[130:131], v[130:131], v[208:209]
    v_pk_mul_f32 v[132:133], v[132:133], v[208:209]
    v_pk_mul_f32 v[134:135], v[134:135], v[208:209]
    v_pk_mul_f32 v[136:137], v[136:137], v[208:209]
    v_pk_mul_f32 v[138:139], v[138:139], v[208:209]
    v_pk_mul_f32 v[140:141], v[140:141], v[208:209]
    v_pk_mul_f32 v[142:143], v[142:143], v[208:209]
    v_pk_mul_f32 v[144:145], v[144:145], v[208:209]
    v_pk_mul_f32 v[146:147], v[146:147], v[208:209]
    v_pk_mul_f32 v[148:149], v[148:149], v[208:209]
    v_pk_mul_f32 v[150:151], v[150:151], v[208:209]
    v_cvt_pk_bf16_f32 v116, v128, v129
    v_cvt_pk_bf16_f32 v117, v130, v131
    v_cvt_pk_bf16_f32 v118, v132, v133
    v_cvt_pk_bf16_f32 v119, v134, v135
    v_cvt_pk_bf16_f32 v120, v136, v137
    v_cvt_pk_bf16_f32 v121, v138, v139
    v_cvt_pk_bf16_f32 v122, v140, v141
    v_cvt_pk_bf16_f32 v123, v142, v143
    v_cvt_pk_bf16_f32 v124, v144, v145
    v_cvt_pk_bf16_f32 v125, v146, v147
    v_cvt_pk_bf16_f32 v126, v148, v149
    v_cvt_pk_bf16_f32 v127, v150, v151
    ds_write_b128 v14, v[116:119] offset:1024
    ds_write_b128 v14, v[120:123] offset:1152
    ds_write_b128 v14, v[124:127] offset:1280
    s_cmp_lg_u32 s62, 7
    s_cbranch_scc1 L_w0_nx2
    v_lshlrev_b32 v128, 16, v184
    v_and_b32 v129, s76, v184
    v_lshlrev_b32 v130, 16, v185
    v_and_b32 v131, s76, v185
    v_lshlrev_b32 v132, 16, v186
    v_and_b32 v133, s76, v186
    v_lshlrev_b32 v134, 16, v187
    v_and_b32 v135, s76, v187
    v_lshlrev_b32 v136, 16, v188
    v_and_b32 v137, s76, v188
    v_lshlrev_b32 v138, 16, v189
    v_and_b32 v139, s76, v189
    v_lshlrev_b32 v140, 16, v190
    v_and_b32 v141, s76, v190
    v_lshlrev_b32 v142, 16, v191
    v_and_b32 v143, s76, v191
    v_pk_add_f32 v[128:129], v[128:129], v[206:207]
    v_pk_add_f32 v[130:131], v[130:131], v[206:207]
    v_pk_add_f32 v[132:133], v[132:133], v[206:207]
    v_pk_add_f32 v[134:135], v[134:135], v[206:207]
    v_pk_add_f32 v[136:137], v[136:137], v[206:207]
    v_pk_add_f32 v[138:139], v[138:139], v[206:207]
    v_pk_add_f32 v[140:141], v[140:141], v[206:207]
    v_pk_add_f32 v[142:143], v[142:143], v[206:207]
    v_cvt_pk_bf16_f32 v184, v128, v129
    v_cvt_pk_bf16_f32 v185, v130, v131
    v_cvt_pk_bf16_f32 v186, v132, v133
    v_cvt_pk_bf16_f32 v187, v134, v135
    v_cvt_pk_bf16_f32 v188, v136, v137
    v_cvt_pk_bf16_f32 v189, v138, v139
    v_cvt_pk_bf16_f32 v190, v140, v141
    v_cvt_pk_bf16_f32 v191, v142, v143
    v_lshlrev_b32 v128, 16, v184
    v_and_b32 v129, s76, v184
    v_lshlrev_b32 v130, 16, v185
    v_and_b32 v131, s76, v185
    v_lshlrev_b32 v132, 16, v186
    v_and_b32 v133, s76, v186
    v_lshlrev_b32 v134, 16, v187
    v_and_b32 v135, s76, v187
    v_lshlrev_b32 v136, 16, v188
    v_and_b32 v137, s76, v188
    v_lshlrev_b32 v138, 16, v189
    v_and_b32 v139, s76, v189
    v_lshlrev_b32 v140, 16, v190
    v_and_b32 v141, s76, v190
    v_lshlrev_b32 v142, 16, v191
    v_and_b32 v143, s76, v191
    v_pk_mul_f32 v[128:129], v[128:129], v[208:209]
    v_pk_mul_f32 v[130:131], v[130:131], v[208:209]
    v_pk_mul_f32 v[132:133], v[132:133], v[208:209]
    v_pk_mul_f32 v[134:135], v[134:135], v[208:209]
    v_pk_mul_f32 v[136:137], v[136:137], v[208:209]
    v_pk_mul_f32 v[138:139], v[138:139], v[208:209]
    v_pk_mul_f32 v[140:141], v[140:141], v[208:209]
    v_pk_mul_f32 v[142:143], v[142:143], v[208:209]
    v_cvt_pk_bf16_f32 v184, v128, v129
    v_cvt_pk_bf16_f32 v185, v130, v131
    v_cvt_pk_bf16_f32 v186, v132, v133
    v_cvt_pk_bf16_f32 v187, v134, v135
    v_cvt_pk_bf16_f32 v188, v136, v137
    v_cvt_pk_bf16_f32 v189, v138, v139
    v_cvt_pk_bf16_f32 v190, v140, v141
    v_cvt_pk_bf16_f32 v191, v142, v143
    ds_write_b128 v14, v[184:187] offset:1408
    ds_write_b128 v14, v[188:191] offset:1536
L_w0_nx2:
    v_xor_b32 v76, 0, v8
    v_xor_b32 v77, 32, v8
    v_xor_b32 v78, 64, v8
    v_xor_b32 v79, 96, v8
    v_mov_b32 v226, s26
    v_mov_b32 v227, s27
    v_mov_b32 v230, s26
    v_mov_b32 v231, s27
    v_mov_b32 v234, s26
    v_mov_b32 v235, s27
    v_mov_b32 v238, s26
    v_mov_b32 v239, s27
    s_mov_b32 s14, 0xff00ff00
    s_mov_b32 s15, 0xff00ff00
    ds_read_b128 v[80:83], v10 offset:1024
    ds_read_b128 v[84:87], v10 offset:1088
    ds_read_b128 v[88:91], v10 offset:1152
    ds_read_b128 v[92:95], v10 offset:1216
    ds_read_b128 v[96:99], v10 offset:1280
    ds_read_b128 v[100:103], v10 offset:1344
Lfw_17:
    ds_read_b32 v4, v2 offset:56
    s_waitcnt lgkmcnt(0)
    v_readfirstlane_b32 s11, v4
    s_nop 0
    s_cmp_ge_u32 s11, 3
    s_cbranch_scc1 Lfd_18
    s_sub_u32 s42, s42, 1
    s_cbranch_scc0 Lfw_17
    s_branch L_abort
Lfd_18:
    ds_read_b64_tr_b16 v[128:129], v76 offset:0
    ds_read_b64_tr_b16 v[130:131], v76 offset:512
    ds_read_b64_tr_b16 v[152:153], v77 offset:0
    ds_read_b64_tr_b16 v[154:155], v77 offset:512
    ds_read_b64_tr_b16 v[176:177], v78 offset:0
    ds_read_b64_tr_b16 v[178:179], v78 offset:512
    ds_read_b64_tr_b16 v[200:201], v79 offset:0
    ds_read_b64_tr_b16 v[202:203], v79 offset:512
    ds_read_b64_tr_b16 v[132:133], v76 offset:4096
    ds_read_b64_tr_b16 v[134:135], v76 offset:4608
    ds_read_b64_tr_b16 v[156:157], v77 offset:4096
    ds_read_b64_tr_b16 v[158:159], v77 offset:4608
    ds_read_b64_tr_b16 v[180:181], v78 offset:4096
    ds_read_b64_tr_b16 v[182:183], v78 offset:4608
    ds_read_b64_tr_b16 v[204:205], v79 offset:4096
    ds_read_b64_tr_b16 v[206:207], v79 offset:4608
    ds_read_b64_tr_b16 v[136:137], v76 offset:8192
    ds_read_b64_tr_b16 v[138:139], v76 offset:8704
    ds_read_b64_tr_b16 v[160:161], v77 offset:8192
    ds_read_b64_tr_b16 v[162:163], v77 offset:8704
    ds_read_b64_tr_b16 v[184:185], v78 offset:8192
    ds_read_b64_tr_b16 v[186:187], v78 offset:8704
    ds_read_b64_tr_b16 v[208:209], v79 offset:8192
    ds_read_b64_tr_b16 v[210:211], v79 offset:8704
    ds_read_b64_tr_b16 v[140:141], v76 offset:12288
    ds_read_b64_tr_b16 v[142:143], v76 offset:12800
    ds_read_b64_tr_b16 v[164:165], v77 offset:12288
    ds_read_b64_tr_b16 v[166:167], v77 offset:12800
    ds_read_b64_tr_b16 v[188:189], v78 offset:12288
    ds_read_b64_tr_b16 v[190:191], v78 offset:12800
    ds_read_b64_tr_b16 v[212:213], v79 offset:12288
    ds_read_b64_tr_b16 v[214:215], v79 offset:12800
    ds_read_b64_tr_b16 v[144:145], v76 offset:16384
    ds_read_b64_tr_b16 v[146:147], v76 offset:16896
    ds_read_b64_tr_b16 v[168:169], v77 offset:16384
    ds_read_b64_tr_b16 v[170:171], v77 offset:16896
    ds_read_b64_tr_b16 v[192:193], v78 offset:16384
    ds_read_b64_tr_b16 v[194:195], v78 offset:16896
    ds_read_b64_tr_b16 v[216:217], v79 offset:16384
    ds_read_b64_tr_b16 v[218:219], v79 offset:16896
    ds_read_b64_tr_b16 v[148:149], v76 offset:20480
    ds_read_b64_tr_b16 v[150:151], v76 offset:20992
    ds_read_b64_tr_b16 v[172:173], v77 offset:20480
    ds_read_b64_tr_b16 v[174:175], v77 offset:20992
    ds_read_b64_tr_b16 v[196:197], v78 offset:20480
    ds_read_b64_tr_b16 v[198:199], v78 offset:20992
    ds_read_b64_tr_b16 v[220:221], v79 offset:20480
    ds_read_b64_tr_b16 v[222:223], v79 offset:20992
    s_waitcnt lgkmcnt(15)
    v_mfma_f32_16x16x32_bf16 v[104:107], v[128:131], v[80:83], 0
    v_mfma_f32_16x16x32_bf16 v[108:111], v[152:155], v[80:83], 0
    v_mfma_f32_16x16x32_bf16 v[112:115], v[176:179], v[80:83], 0
    v_mfma_f32_16x16x32_bf16 v[116:119], v[200:203], v[80:83], 0
    s_waitcnt lgkmcnt(15)
    v_mfma_f32_16x16x32_bf16 v[104:107], v[132:135], v[84:87], v[104:107]
    v_mfma_f32_16x16x32_bf16 v[108:111], v[156:159], v[84:87], v[108:111]
    v_mfma_f32_16x16x32_bf16 v[112:115], v[180:183], v[84:87], v[112:115]
    v_mfma_f32_16x16x32_bf16 v[116:119], v[204:207], v[84:87], v[116:119]
    s_waitcnt lgkmcnt(15)
    v_mfma_f32_16x16x32_bf16 v[104:107], v[136:139], v[88:91], v[104:107]
    v_mfma_f32_16x16x32_bf16 v[108:111], v[160:163], v[88:91], v[108:111]
    v_mfma_f32_16x16x32_bf16 v[112:115], v[184:187], v[88:91], v[112:115]
    v_mfma_f32_16x16x32_bf16 v[116:119], v[208:211], v[88:91], v[116:119]
    s_waitcnt lgkmcnt(15)
    v_mfma_f32_16x16x32_bf16 v[104:107], v[140:143], v[92:95], v[104:107]
    v_mfma_f32_16x16x32_bf16 v[108:111], v[164:167], v[92:95], v[108:111]
    v_mfma_f32_16x16x32_bf16 v[112:115], v[188:191], v[92:95], v[112:115]
    v_mfma_f32_16x16x32_bf16 v[116:119], v[212:215], v[92:95], v[116:119]
    s_waitcnt lgkmcnt(8)
    v_mfma_f32_16x16x32_bf16 v[104:107], v[144:147], v[96:99], v[104:107]
    v_mfma_f32_16x16x32_bf16 v[108:111], v[168:171], v[96:99], v[108:111]
    v_mfma_f32_16x16x32_bf16 v[112:115], v[192:195], v[96:99], v[112:115]
    v_mfma_f32_16x16x32_bf16 v[116:119], v[216:219], v[96:99], v[116:119]
    s_waitcnt lgkmcnt(0)
    v_mfma_f32_16x16x32_bf16 v[104:107], v[148:151], v[100:103], v[104:107]
    v_mfma_f32_16x16x32_bf16 v[108:111], v[172:175], v[100:103], v[108:111]
    v_mfma_f32_16x16x32_bf16 v[112:115], v[196:199], v[100:103], v[112:115]
    v_mfma_f32_16x16x32_bf16 v[116:119], v[220:223], v[100:103], v[116:119]
    s_cmp_lg_u32 s62, 7
    s_cbranch_scc1 L_w0_nx3
    ds_read_b128 v[80:83], v10 offset:1408
    ds_read_b128 v[84:87], v10 offset:1472
    ds_read_b128 v[88:91], v10 offset:1536
    ds_read_b64_tr_b16 v[128:129], v76 offset:24576
    ds_read_b64_tr_b16 v[130:131], v76 offset:25088
    ds_read_b64_tr_b16 v[152:153], v77 offset:24576
    ds_read_b64_tr_b16 v[154:155], v77 offset:25088
    ds_read_b64_tr_b16 v[176:177], v78 offset:24576
    ds_read_b64_tr_b16 v[178:179], v78 offset:25088
    ds_read_b64_tr_b16 v[200:201], v79 offset:24576
    ds_read_b64_tr_b16 v[202:203], v79 offset:25088
    ds_read_b64_tr_b16 v[132:133], v76 offset:28672
    ds_read_b64_tr_b16 v[134:135], v76 offset:29184
    ds_read_b64_tr_b16 v[156:157], v77 offset:28672
    ds_read_b64_tr_b16 v[158:159], v77 offset:29184
    ds_read_b64_tr_b16 v[180:181], v78 offset:28672
    ds_read_b64_tr_b16 v[182:183], v78 offset:29184
    ds_read_b64_tr_b16 v[204:205], v79 offset:28672
    ds_read_b64_tr_b16 v[206:207], v79 offset:29184
    ds_read_b64_tr_b16 v[136:137], v76 offset:32768
    ds_read_b64_tr_b16 v[138:139], v76 offset:33280
    ds_read_b64_tr_b16 v[160:161], v77 offset:32768
    ds_read_b64_tr_b16 v[162:163], v77 offset:33280
    ds_read_b64_tr_b16 v[184:185], v78 offset:32768
    ds_read_b64_tr_b16 v[186:187], v78 offset:33280
    ds_read_b64_tr_b16 v[208:209], v79 offset:32768
    ds_read_b64_tr_b16 v[210:211], v79 offset:33280
    v_mov_b32 v64, 0
    v_mov_b32 v65, 0
    v_mov_b32 v66, s26
    v_mov_b32 v67, s27
    s_lshl_b32 s11, s4, 17
    s_add_u32 s11, s11, 69120
    s_add_u32 s74, s11, 3145728
    buffer_store_dwordx4 v[64:67], v13, s[44:47], s11 offen offset:0
    buffer_store_dwordx4 v[64:67], v13, s[44:47], s11 offen offset:128
    buffer_store_dwordx4 v[64:67], v13, s[44:47], s11 offen offset:256
    buffer_store_dwordx4 v[64:67], v13, s[44:47], s11 offen offset:384
    s_waitcnt lgkmcnt(0)
    v_mfma_f32_16x16x32_bf16 v[104:107], v[128:131], v[80:83], v[104:107]
    v_mfma_f32_16x16x32_bf16 v[108:111], v[152:155], v[80:83], v[108:111]
    v_mfma_f32_16x16x32_bf16 v[112:115], v[176:179], v[80:83], v[112:115]
    v_mfma_f32_16x16x32_bf16 v[116:119], v[200:203], v[80:83], v[116:119]
    v_mfma_f32_16x16x32_bf16 v[104:107], v[132:135], v[84:87], v[104:107]
    v_mfma_f32_16x16x32_bf16 v[108:111], v[156:159], v[84:87], v[108:111]
    v_mfma_f32_16x16x32_bf16 v[112:115], v[180:183], v[84:87], v[112:115]
    v_mfma_f32_16x16x32_bf16 v[116:119], v[204:207], v[84:87], v[116:119]
    v_mfma_f32_16x16x32_bf16 v[104:107], v[136:139], v[88:91], v[104:107]
    v_mfma_f32_16x16x32_bf16 v[108:111], v[160:163], v[88:91], v[108:111]
    v_mfma_f32_16x16x32_bf16 v[112:115], v[184:187], v[88:91], v[112:115]
    v_mfma_f32_16x16x32_bf16 v[116:119], v[208:211], v[88:91], v[116:119]
L_w0_nx3:
    s_nop 5
    v_cndmask_b32 v224, v104, v106, s[14:15]
    v_cndmask_b32 v225, v105, v107, s[14:15]
    buffer_store_dwordx4 v[224:227], v13, s[44:47], s77 offen offset:0
    v_cndmask_b32 v228, v108, v110, s[14:15]
    v_cndmask_b32 v229, v109, v111, s[14:15]
    buffer_store_dwordx4 v[228:231], v13, s[44:47], s77 offen offset:128
    v_cndmask_b32 v232, v112, v114, s[14:15]
    v_cndmask_b32 v233, v113, v115, s[14:15]
    buffer_store_dwordx4 v[232:235], v13, s[44:47], s77 offen offset:256
    v_cndmask_b32 v236, v116, v118, s[14:15]
    v_cndmask_b32 v237, v117, v119, s[14:15]
    buffer_store_dwordx4 v[236:239], v13, s[44:47], s77 offen offset:384
    s_mov_b32 s63, 1
    s_branch L_w0_g
L_w0_np:
    ds_write_b32 v7, v2
    s_waitcnt lgkmcnt(0)
    s_barrier
    s_add_u32 s26, s26, 0x9e3779b9
    s_addc_u32 s27, s27, 0x7f4a7c15
    s_mov_b32 s63, 0
    s_mov_b32 s62, 0
    s_mov_b32 s77, 0
    s_mov_b32 s74, 0
    v_mov_b32 v13, 0
L_w0_g:
    s_setprio 0
    s_mov_b32 s12, 0
    s_branch L_v
L_roles:
    s_cmp_eq_u32 s3, 4
    s_cbranch_scc1 L_r_w0
    s_cmp_eq_u32 s3, 0
    s_cbranch_scc1 L_r_tail
    s_cmp_ge_u32 s3, 5
    s_cbranch_scc1 L_r_tail
    s_sub_u32 s12, s3, 1
    s_cmp_ge_u32 s5, 27
    s_cbranch_scc1 L_fin
    s_cmp_ge_u32 s5, 18
    s_cbranch_scc1 L_ld_wo
    s_cmp_ge_u32 s5, 9
    s_cselect_b32 s56, s32, s30
    s_cselect_b32 s57, s33, s31
    s_cselect_b32 s14, 9, 0
    s_and_b32 s57, s57, 0xffff
    s_mov_b32 s58, 5308416
    s_mov_b32 s59, 0x20000
    s_sub_u32 s14, s5, s14
    s_lshl_b32 s14, s14, 7
    s_mul_i32 s15, s4, 1152
    s_add_u32 s14, s14, s15
    s_mul_i32 s15, s12, 1769472
    s_add_u32 s14, s14, s15
    v_lshrrev_b32 v11, 3, v1
    s_mov_b32 s11, 9216
    v_mul_lo_u32 v9, v11, s11
    v_and_b32 v11, 2, v11
    v_and_b32 v12, 7, v1
    v_xor_b32 v12, v12, v11
    v_xor_b32 v11, 4, v12
    v_lshl_add_u32 v10, v11, 4, v9
    v_lshl_add_u32 v9, v12, 4, v9
    s_mul_i32 s15, s12, 24576
    s_add_u32 s15, s15, 24576
Lfw_19:
    ds_read_b32 v4, v2 offset:12
    s_waitcnt lgkmcnt(0)
    v_readfirstlane_b32 s11, v4
    s_nop 0
    s_cmp_ge_u32 s11, 5
    s_cbranch_scc1 Lfd_20
    s_sleep 1
    s_sub_u32 s42, s42, 1
    s_cbranch_scc0 Lfw_19
    s_branch L_abort
Lfd_20:
    s_mov_b32 m0, s15
    s_nop 0
    buffer_load_dwordx4 v9, s[56:59], s14 offen nt lds
    s_add_u32 s14, s14, 73728
    s_add_u32 s15, s15, 1024
    s_mov_b32 m0, s15
    s_nop 0
    buffer_load_dwordx4 v10, s[56:59], s14 offen nt lds
    s_add_u32 s14, s14, 73728
    s_add_u32 s15, s15, 1024
    s_mov_b32 m0, s15
    s_nop 0
    buffer_load_dwordx4 v9, s[56:59], s14 offen nt lds
    s_add_u32 s14, s14, 73728
    s_add_u32 s15, s15, 1024
    s_mov_b32 m0, s15
    s_nop 0
    buffer_load_dwordx4 v10, s[56:59], s14 offen nt lds
    s_add_u32 s14, s14, 73728
    s_add_u32 s15, s15, 1024
    s_waitcnt vmcnt(3)
L_gt4:
    ds_read_b32 v4, v2 offset:28
    s_waitcnt lgkmcnt(0)
    v_readfirstlane_b32 s11, v4
    s_nop 0
    s_cmp_lg_u32 s11, 0
    s_cbranch_scc1 L_gf4
    s_mov_b32 m0, s15
    s_nop 0
    buffer_load_dwordx4 v9, s[56:59], s14 offen nt lds
    s_add_u32 s14, s14, 73728
    s_add_u32 s15, s15, 1024
    s_waitcnt vmcnt(3)
L_gt5:
    ds_read_b32 v4, v2 offset:28
    s_waitcnt lgkmcnt(0)
    v_readfirstlane_b32 s11, v4
    s_nop 0
    s_cmp_lg_u32 s11, 0
    s_cbranch_scc1 L_gf5
    s_mov_b32 m0, s15
    s_nop 0
    buffer_load_dwordx4 v10, s[56:59], s14 offen nt lds
    s_add_u32 s14, s14, 73728
    s_add_u32 s15, s15, 1024
    s_waitcnt vmcnt(3)
L_gt6:
    ds_read_b32 v4, v2 offset:28
    s_waitcnt lgkmcnt(0)
    v_readfirstlane_b32 s11, v4
    s_nop 0
    s_cmp_lg_u32 s11, 0
    s_cbranch_scc1 L_gf6
    s_mov_b32 m0, s15
    s_nop 0
    buffer_load_dwordx4 v9, s[56:59], s14 offen nt lds
    s_add_u32 s14, s14, 73728
    s_add_u32 s15, s15, 1024
    s_waitcnt vmcnt(3)
L_gt7:
    ds_read_b32 v4, v2 offset:28
    s_waitcnt lgkmcnt(0)
    v_readfirstlane_b32 s11, v4
    s_nop 0
    s_cmp_lg_u32 s11, 0
    s_cbranch_scc1 L_gf7
    s_mov_b32 m0, s15
    s_nop 0
    buffer_load_dwordx4 v10, s[56:59], s14 offen nt lds
    s_add_u32 s14, s14, 73728
    s_add_u32 s15, s15, 1024
    s_waitcnt vmcnt(3)
L_gt8:
    ds_read_b32 v4, v2 offset:28
    s_waitcnt lgkmcnt(0)
    v_readfirstlane_b32 s11, v4
    s_nop 0
    s_cmp_lg_u32 s11, 0
    s_cbranch_scc1 L_gf8
    s_mov_b32 m0, s15
    s_nop 0
    buffer_load_dwordx4 v9, s[56:59], s14 offen nt lds
    s_add_u32 s14, s14, 73728
    s_add_u32 s15, s15, 1024
    s_waitcnt vmcnt(3)
L_gt9:
    ds_read_b32 v4, v2 offset:28
    s_waitcnt lgkmcnt(0)
    v_readfirstlane_b32 s11, v4
    s_nop 0
    s_cmp_lg_u32 s11, 0
    s_cbranch_scc1 L_gf9
    s_mov_b32 m0, s15
    s_nop 0
    buffer_load_dwordx4 v10, s[56:59], s14 offen nt lds
    s_add_u32 s14, s14, 73728
    s_add_u32 s15, s15, 1024
    s_waitcnt vmcnt(3)
L_gt10:
    ds_read_b32 v4, v2 offset:28
    s_waitcnt lgkmcnt(0)
    v_readfirstlane_b32 s11, v4
    s_nop 0
    s_cmp_lg_u32 s11, 0
    s_cbranch_scc1 L_gf10
    s_mov_b32 m0, s15
    s_nop 0
    buffer_load_dwordx4 v9, s[56:59], s14 offen nt lds
    s_add_u32 s14, s14, 73728
    s_add_u32 s15, s15, 1024
    s_waitcnt vmcnt(3)
L_gt11:
    ds_read_b32 v4, v2 offset:28
    s_waitcnt lgkmcnt(0)
    v_readfirstlane_b32 s11, v4
    s_nop 0
    s_cmp_lg_u32 s11, 0
    s_cbranch_scc1 L_gf11
    s_mov_b32 m0, s15
    s_nop 0
    buffer_load_dwordx4 v10, s[56:59], s14 offen nt lds
    s_add_u32 s14, s14, 73728
    s_add_u32 s15, s15, 1024
    s_waitcnt vmcnt(3)
L_gt12:
    ds_read_b32 v4, v2 offset:28
    s_waitcnt lgkmcnt(0)
    v_readfirstlane_b32 s11, v4
    s_nop 0
    s_cmp_lg_u32 s11, 0
    s_cbranch_scc1 L_gf12
    s_mov_b32 m0, s15
    s_nop 0
    buffer_load_dwordx4 v9, s[56:59], s14 offen nt lds
    s_add_u32 s14, s14, 73728
    s_add_u32 s15, s15, 1024
    s_waitcnt vmcnt(3)
L_gt13:
    ds_read_b32 v4, v2 offset:28
    s_waitcnt lgkmcnt(0)
    v_readfirstlane_b32 s11, v4
    s_nop 0
    s_cmp_lg_u32 s11, 0
    s_cbranch_scc1 L_gf13
    s_mov_b32 m0, s15
    s_nop 0
    buffer_load_dwordx4 v10, s[56:59], s14 offen nt lds
    s_add_u32 s14, s14, 73728
    s_add_u32 s15, s15, 1024
    s_waitcnt vmcnt(3)
L_gt14:
    ds_read_b32 v4, v2 offset:28
    s_waitcnt lgkmcnt(0)
    v_readfirstlane_b32 s11, v4
    s_nop 0
    s_cmp_lg_u32 s11, 0
    s_cbranch_scc1 L_gf14
    s_mov_b32 m0, s15
    s_nop 0
    buffer_load_dwordx4 v9, s[56:59], s14 offen nt lds
    s_add_u32 s14, s14, 73728
    s_add_u32 s15, s15, 1024
    s_waitcnt vmcnt(3)
L_gt15:
    ds_read_b32 v4, v2 offset:28
    s_waitcnt lgkmcnt(0)
    v_readfirstlane_b32 s11, v4
    s_nop 0
    s_cmp_lg_u32 s11, 0
    s_cbranch_scc1 L_gf15
    s_mov_b32 m0, s15
    s_nop 0
    buffer_load_dwordx4 v10, s[56:59], s14 offen nt lds
    s_add_u32 s14, s14, 73728
    s_add_u32 s15, s15, 1024
    s_waitcnt vmcnt(3)
L_gt16:
    ds_read_b32 v4, v2 offset:28
    s_waitcnt lgkmcnt(0)
    v_readfirstlane_b32 s11, v4
    s_nop 0
    s_cmp_lg_u32 s11, 0
    s_cbranch_scc1 L_gf16
    s_mov_b32 m0, s15
    s_nop 0
    buffer_load_dwordx4 v9, s[56:59], s14 offen nt lds
    s_add_u32 s14, s14, 73728
    s_add_u32 s15, s15, 1024
    s_waitcnt vmcnt(3)
L_gt17:
    ds_read_b32 v4, v2 offset:28
    s_waitcnt lgkmcnt(0)
    v_readfirstlane_b32 s11, v4
    s_nop 0
    s_cmp_lg_u32 s11, 0
    s_cbranch_scc1 L_gf17
    s_mov_b32 m0, s15
    s_nop 0
    buffer_load_dwordx4 v10, s[56:59], s14 offen nt lds
    s_add_u32 s14, s14, 73728
    s_add_u32 s15, s15, 1024
    s_waitcnt vmcnt(3)
L_gt18:
    ds_read_b32 v4, v2 offset:28
    s_waitcnt lgkmcnt(0)
    v_readfirstlane_b32 s11, v4
    s_nop 0
    s_cmp_lg_u32 s11, 0
    s_cbranch_scc1 L_gf18
    s_mov_b32 m0, s15
    s_nop 0
    buffer_load_dwordx4 v9, s[56:59], s14 offen nt lds
    s_add_u32 s14, s14, 73728
    s_add_u32 s15, s15, 1024
    s_waitcnt vmcnt(3)
L_gt19:
    ds_read_b32 v4, v2 offset:28
    s_waitcnt lgkmcnt(0)
    v_readfirstlane_b32 s11, v4
    s_nop 0
    s_cmp_lg_u32 s11, 0
    s_cbranch_scc1 L_gf19
    s_mov_b32 m0, s15
    s_nop 0
    buffer_load_dwordx4 v10, s[56:59], s14 offen nt lds
    s_add_u32 s14, s14, 73728
    s_add_u32 s15, s15, 1024
    s_waitcnt vmcnt(3)
L_gt20:
    ds_read_b32 v4, v2 offset:28
    s_waitcnt lgkmcnt(0)
    v_readfirstlane_b32 s11, v4
    s_nop 0
    s_cmp_lg_u32 s11, 0
    s_cbranch_scc1 L_gf20
    s_mov_b32 m0, s15
    s_nop 0
    buffer_load_dwordx4 v9, s[56:59], s14 offen nt lds
    s_add_u32 s14, s14, 73728
    s_add_u32 s15, s15, 1024
    s_waitcnt vmcnt(3)
L_gt21:
    ds_read_b32 v4, v2 offset:28
    s_waitcnt lgkmcnt(0)
    v_readfirstlane_b32 s11, v4
    s_nop 0
    s_cmp_lg_u32 s11, 0
    s_cbranch_scc1 L_gf21
    s_mov_b32 m0, s15
    s_nop 0
    buffer_load_dwordx4 v10, s[56:59], s14 offen nt lds
    s_add_u32 s14, s14, 73728
    s_add_u32 s15, s15, 1024
    s_waitcnt vmcnt(3)
L_gt22:
    ds_read_b32 v4, v2 offset:28
    s_waitcnt lgkmcnt(0)
    v_readfirstlane_b32 s11, v4
    s_nop 0
    s_cmp_lg_u32 s11, 0
    s_cbranch_scc1 L_gf22
    s_mov_b32 m0, s15
    s_nop 0
    buffer_load_dwordx4 v9, s[56:59], s14 offen nt lds
    s_add_u32 s14, s14, 73728
    s_add_u32 s15, s15, 1024
    s_waitcnt vmcnt(3)
L_gt23:
    ds_read_b32 v4, v2 offset:28
    s_waitcnt lgkmcnt(0)
    v_readfirstlane_b32 s11, v4
    s_nop 0
    s_cmp_lg_u32 s11, 0
    s_cbranch_scc1 L_gf23
    s_mov_b32 m0, s15
    s_nop 0
    buffer_load_dwordx4 v10, s[56:59], s14 offen nt lds
    s_add_u32 s14, s14, 73728
    s_add_u32 s15, s15, 1024
    s_branch L_gdone
L_gf4:
    s_mov_b32 m0, s15
    s_nop 0
    buffer_load_dwordx4 v9, s[56:59], s14 offen nt lds
    s_add_u32 s14, s14, 73728
    s_add_u32 s15, s15, 1024
L_gf5:
    s_mov_b32 m0, s15
    s_nop 0
    buffer_load_dwordx4 v10, s[56:59], s14 offen nt lds
    s_add_u32 s14, s14, 73728
    s_add_u32 s15, s15, 1024
L_gf6:
    s_mov_b32 m0, s15
    s_nop 0
    buffer_load_dwordx4 v9, s[56:59], s14 offen nt lds
    s_add_u32 s14, s14, 73728
    s_add_u32 s15, s15, 1024
L_gf7:
    s_mov_b32 m0, s15
    s_nop 0
    buffer_load_dwordx4 v10, s[56:59], s14 offen nt lds
    s_add_u32 s14, s14, 73728
    s_add_u32 s15, s15, 1024
L_gf8:
    s_mov_b32 m0, s15
    s_nop 0
    buffer_load_dwordx4 v9, s[56:59], s14 offen nt lds
    s_add_u32 s14, s14, 73728
    s_add_u32 s15, s15, 1024
L_gf9:
    s_mov_b32 m0, s15
    s_nop 0
    buffer_load_dwordx4 v10, s[56:59], s14 offen nt lds
    s_add_u32 s14, s14, 73728
    s_add_u32 s15, s15, 1024
L_gf10:
    s_mov_b32 m0, s15
    s_nop 0
    buffer_load_dwordx4 v9, s[56:59], s14 offen nt lds
    s_add_u32 s14, s14, 73728
    s_add_u32 s15, s15, 1024
L_gf11:
    s_mov_b32 m0, s15
    s_nop 0
    buffer_load_dwordx4 v10, s[56:59], s14 offen nt lds
    s_add_u32 s14, s14, 73728
    s_add_u32 s15, s15, 1024
L_gf12:
    s_mov_b32 m0, s15
    s_nop 0
    buffer_load_dwordx4 v9, s[56:59], s14 offen nt lds
    s_add_u32 s14, s14, 73728
    s_add_u32 s15, s15, 1024
L_gf13:
    s_mov_b32 m0, s15
    s_nop 0
    buffer_load_dwordx4 v10, s[56:59], s14 offen nt lds
    s_add_u32 s14, s14, 73728
    s_add_u32 s15, s15, 1024
L_gf14:
    s_mov_b32 m0, s15
    s_nop 0
    buffer_load_dwordx4 v9, s[56:59], s14 offen nt lds
    s_add_u32 s14, s14, 73728
    s_add_u32 s15, s15, 1024
L_gf15:
    s_mov_b32 m0, s15
    s_nop 0
    buffer_load_dwordx4 v10, s[56:59], s14 offen nt lds
    s_add_u32 s14, s14, 73728
    s_add_u32 s15, s15, 1024
L_gf16:
    s_mov_b32 m0, s15
    s_nop 0
    buffer_load_dwordx4 v9, s[56:59], s14 offen nt lds
    s_add_u32 s14, s14, 73728
    s_add_u32 s15, s15, 1024
L_gf17:
    s_mov_b32 m0, s15
    s_nop 0
    buffer_load_dwordx4 v10, s[56:59], s14 offen nt lds
    s_add_u32 s14, s14, 73728
    s_add_u32 s15, s15, 1024
L_gf18:
    s_mov_b32 m0, s15
    s_nop 0
    buffer_load_dwordx4 v9, s[56:59], s14 offen nt lds
    s_add_u32 s14, s14, 73728
    s_add_u32 s15, s15, 1024
L_gf19:
    s_mov_b32 m0, s15
    s_nop 0
    buffer_load_dwordx4 v10, s[56:59], s14 offen nt lds
    s_add_u32 s14, s14, 73728
    s_add_u32 s15, s15, 1024
L_gf20:
    s_mov_b32 m0, s15
    s_nop 0
    buffer_load_dwordx4 v9, s[56:59], s14 offen nt lds
    s_add_u32 s14, s14, 73728
    s_add_u32 s15, s15, 1024
L_gf21:
    s_mov_b32 m0, s15
    s_nop 0
    buffer_load_dwordx4 v10, s[56:59], s14 offen nt lds
    s_add_u32 s14, s14, 73728
    s_add_u32 s15, s15, 1024
L_gf22:
    s_mov_b32 m0, s15
    s_nop 0
    buffer_load_dwordx4 v9, s[56:59], s14 offen nt lds
    s_add_u32 s14, s14, 73728
    s_add_u32 s15, s15, 1024
L_gf23:
    s_mov_b32 m0, s15
    s_nop 0
    buffer_load_dwordx4 v10, s[56:59], s14 offen nt lds
    s_add_u32 s14, s14, 73728
    s_add_u32 s15, s15, 1024
L_gdone:
    s_waitcnt vmcnt(0)
    s_mov_b64 exec, 1
    ds_add_u32 v2, v3 offset:16
    s_mov_b64 exec, -1
    s_branch L_fin
L_ld_wo:
    s_mov_b32 s60, s34
    s_and_b32 s61, s35, 0xffff
    s_mov_b32 s62, 5308416
    s_mov_b32 s63, 0x20000
    s_mov_b32 s52, s24
    s_and_b32 s53, s25, 0xffff
    s_mov_b32 s54, 4718592
    s_mov_b32 s55, 0x20000
    s_sub_u32 s77, s5, 18
    s_lshl_b32 s77, s77, 7
    v_lshrrev_b32 v11, 3, v1
    s_mov_b32 s11, 1152
    v_mul_lo_u32 v9, v11, s11
    v_and_b32 v11, 2, v11
    v_and_b32 v12, 7, v1
    v_xor_b32 v12, v12, v11
    v_xor_b32 v11, 4, v12
    v_lshl_add_u32 v10, v11, 4, v9
    v_lshl_add_u32 v9, v12, 4, v9
    s_sub_u32 s12, s3, 1
    s_mul_i32 s14, s4, 589824
    s_add_u32 s14, s14, s77
    s_mul_i32 s15, s12, 202752
    s_add_u32 s14, s14, s15
    s_mul_i32 s15, s12, 22528
    s_add_u32 s15, s15, 24576
    s_mov_b32 s74, s77
    s_mov_b32 s14, s72
    s_mov_b32 s15, s73
    s_mov_b32 m0, s15
    s_nop 0
    buffer_load_dwordx4 v9, s[52:55], s14 offen nt lds
    s_add_u32 s14, s14, 9216
    s_add_u32 s15, s15, 1024
    s_mov_b32 m0, s15
    s_nop 0
    buffer_load_dwordx4 v10, s[52:55], s14 offen nt lds
    s_add_u32 s14, s14, 9216
    s_add_u32 s15, s15, 1024
    s_mov_b32 m0, s15
    s_nop 0
    buffer_load_dwordx4 v9, s[52:55], s14 offen nt lds
    s_add_u32 s14, s14, 9216
    s_add_u32 s15, s15, 1024
    s_mov_b32 m0, s15
    s_nop 0
    buffer_load_dwordx4 v10, s[52:55], s14 offen nt lds
    s_add_u32 s14, s14, 9216
    s_add_u32 s15, s15, 1024
    s_mov_b32 m0, s15
    s_nop 0
    buffer_load_dwordx4 v9, s[52:55], s14 offen nt lds
    s_add_u32 s14, s14, 9216
    s_add_u32 s15, s15, 1024
    s_mov_b32 m0, s15
    s_nop 0
    buffer_load_dwordx4 v10, s[52:55], s14 offen nt lds
    s_add_u32 s14, s14, 9216
    s_add_u32 s15, s15, 1024
    s_mov_b32 m0, s15
    s_nop 0
    buffer_load_dwordx4 v9, s[52:55], s14 offen nt lds
    s_add_u32 s14, s14, 9216
    s_add_u32 s15, s15, 1024
    s_mov_b32 m0, s15
    s_nop 0
    buffer_load_dwordx4 v10, s[52:55], s14 offen nt lds
    s_add_u32 s14, s14, 9216
    s_add_u32 s15, s15, 1024
    s_mov_b32 m0, s15
    s_nop 0
    buffer_load_dwordx4 v9, s[52:55], s14 offen nt lds
    s_add_u32 s14, s14, 9216
    s_add_u32 s15, s15, 1024
    s_mov_b32 m0, s15
    s_nop 0
    buffer_load_dwordx4 v10, s[52:55], s14 offen nt lds
    s_add_u32 s14, s14, 9216
    s_add_u32 s15, s15, 1024
    s_mov_b32 m0, s15
    s_nop 0
    buffer_load_dwordx4 v9, s[52:55], s14 offen nt lds
    s_add_u32 s14, s14, 9216
    s_add_u32 s15, s15, 1024
    s_mov_b32 m0, s15
    s_nop 0
    buffer_load_dwordx4 v10, s[52:55], s14 offen nt lds
    s_add_u32 s14, s14, 9216
    s_add_u32 s15, s15, 1024
    s_cmp_eq_u32 s12, 2
    s_cbranch_scc1 L_ld_wo2
    s_mov_b32 m0, s15
    s_nop 0
    buffer_load_dwordx4 v9, s[52:55], s14 offen nt lds
    s_add_u32 s14, s14, 9216
    s_add_u32 s15, s15, 1024
    s_mov_b32 m0, s15
    s_nop 0
    buffer_load_dwordx4 v10, s[52:55], s14 offen nt lds
    s_add_u32 s14, s14, 9216
    s_add_u32 s15, s15, 1024
L_ld_wo2:
    s_mul_i32 s14, s4, 663552
    s_add_u32 s14, s14, s74
    s_mul_i32 s15, s12, 221184
    s_add_u32 s14, s14, s15
    s_mul_i32 s15, s12, 24576
    s_add_u32 s15, s15, 90112
    s_waitcnt vmcnt(0)
    s_mov_b64 exec, 1
    ds_add_u32 v2, v3 offset:16
    s_mov_b64 exec, -1
    s_waitcnt lgkmcnt(0)
    s_barrier
Lfw_21:
    ds_read_b32 v4, v2 offset:36
    s_waitcnt lgkmcnt(0)
    v_readfirstlane_b32 s11, v4
    s_nop 0
    s_cmp_ge_u32 s11, 4
    s_cbranch_scc1 Lfd_22
    s_sub_u32 s42, s42, 1
    s_cbranch_scc0 Lfw_21
    s_branch L_abort
Lfd_22:
    s_mov_b32 m0, s15
    s_nop 0
    buffer_load_dwordx4 v9, s[60:63], s14 offen nt lds
    s_add_u32 s14, s14, 9216
    s_add_u32 s15, s15, 1024
    s_mov_b32 m0, s15
    s_nop 0
    buffer_load_dwordx4 v10, s[60:63], s14 offen nt lds
    s_add_u32 s14, s14, 9216
    s_add_u32 s15, s15, 1024
    s_mov_b32 m0, s15
    s_nop 0
    buffer_load_dwordx4 v9, s[60:63], s14 offen nt lds
    s_add_u32 s14, s14, 9216
    s_add_u32 s15, s15, 1024
    s_mov_b32 m0, s15
    s_nop 0
    buffer_load_dwordx4 v10, s[60:63], s14 offen nt lds
    s_add_u32 s14, s14, 9216
    s_add_u32 s15, s15, 1024
    s_mov_b32 m0, s15
    s_nop 0
    buffer_load_dwordx4 v9, s[60:63], s14 offen nt lds
    s_add_u32 s14, s14, 9216
    s_add_u32 s15, s15, 1024
    s_mov_b32 m0, s15
    s_nop 0
    buffer_load_dwordx4 v10, s[60:63], s14 offen nt lds
    s_add_u32 s14, s14, 9216
    s_add_u32 s15, s15, 1024
    s_mov_b32 m0, s15
    s_nop 0
    buffer_load_dwordx4 v9, s[60:63], s14 offen nt lds
    s_add_u32 s14, s14, 9216
    s_add_u32 s15, s15, 1024
    s_mov_b32 m0, s15
    s_nop 0
    buffer_load_dwordx4 v10, s[60:63], s14 offen nt lds
    s_add_u32 s14, s14, 9216
    s_add_u32 s15, s15, 1024
    s_mov_b32 m0, s15
    s_nop 0
    buffer_load_dwordx4 v9, s[60:63], s14 offen nt lds
    s_add_u32 s14, s14, 9216
    s_add_u32 s15, s15, 1024
    s_mov_b32 m0, s15
    s_nop 0
    buffer_load_dwordx4 v10, s[60:63], s14 offen nt lds
    s_add_u32 s14, s14, 9216
    s_add_u32 s15, s15, 1024
    s_mov_b32 m0, s15
    s_nop 0
    buffer_load_dwordx4 v9, s[60:63], s14 offen nt lds
    s_add_u32 s14, s14, 9216
    s_add_u32 s15, s15, 1024
    s_mov_b32 m0, s15
    s_nop 0
    buffer_load_dwordx4 v10, s[60:63], s14 offen nt lds
    s_add_u32 s14, s14, 9216
    s_add_u32 s15, s15, 1024
    s_mov_b32 m0, s15
    s_nop 0
    buffer_load_dwordx4 v9, s[60:63], s14 offen nt lds
    s_add_u32 s14, s14, 9216
    s_add_u32 s15, s15, 1024
    s_mov_b32 m0, s15
    s_nop 0
    buffer_load_dwordx4 v10, s[60:63], s14 offen nt lds
    s_add_u32 s14, s14, 9216
    s_add_u32 s15, s15, 1024
    s_mov_b32 m0, s15
    s_nop 0
    buffer_load_dwordx4 v9, s[60:63], s14 offen nt lds
    s_add_u32 s14, s14, 9216
    s_add_u32 s15, s15, 1024
    s_mov_b32 m0, s15
    s_nop 0
    buffer_load_dwordx4 v10, s[60:63], s14 offen nt lds
    s_add_u32 s14, s14, 9216
    s_add_u32 s15, s15, 1024
    s_mov_b32 m0, s15
    s_nop 0
    buffer_load_dwordx4 v9, s[60:63], s14 offen nt lds
    s_add_u32 s14, s14, 9216
    s_add_u32 s15, s15, 1024
    s_mov_b32 m0, s15
    s_nop 0
    buffer_load_dwordx4 v10, s[60:63], s14 offen nt lds
    s_add_u32 s14, s14, 9216
    s_add_u32 s15, s15, 1024
    s_mov_b32 m0, s15
    s_nop 0
    buffer_load_dwordx4 v9, s[60:63], s14 offen nt lds
    s_add_u32 s14, s14, 9216
    s_add_u32 s15, s15, 1024
    s_mov_b32 m0, s15
    s_nop 0
    buffer_load_dwordx4 v10, s[60:63], s14 offen nt lds
    s_add_u32 s14, s14, 9216
    s_add_u32 s15, s15, 1024
    s_mov_b32 m0, s15
    s_nop 0
    buffer_load_dwordx4 v9, s[60:63], s14 offen nt lds
    s_add_u32 s14, s14, 9216
    s_add_u32 s15, s15, 1024
    s_mov_b32 m0, s15
    s_nop 0
    buffer_load_dwordx4 v10, s[60:63], s14 offen nt lds
    s_add_u32 s14, s14, 9216
    s_add_u32 s15, s15, 1024
    s_mov_b32 m0, s15
    s_nop 0
    buffer_load_dwordx4 v9, s[60:63], s14 offen nt lds
    s_add_u32 s14, s14, 9216
    s_add_u32 s15, s15, 1024
    s_mov_b32 m0, s15
    s_nop 0
    buffer_load_dwordx4 v10, s[60:63], s14 offen nt lds
    s_add_u32 s14, s14, 9216
    s_add_u32 s15, s15, 1024
    s_waitcnt vmcnt(0)
    s_mov_b64 exec, 1
    ds_add_u32 v2, v3 offset:20
    s_mov_b64 exec, -1
    s_branch L_fin
L_r_tail:
    s_cmp_lt_u32 s5, 18
    s_cbranch_scc1 L_ffn1
    s_cmp_lt_u32 s5, 27
    s_cbranch_scc1 L_wo
    s_cmp_ge_u32 s5, 31
    s_cbranch_scc1 L_fin
    s_cmp_ge_u32 s12, 2
    s_cbranch_scc1 L_fin
    s_sub_u32 s14, s5, 27
    s_lshl_b32 s14, s14, 1
    s_add_u32 s14, s14, s12
    s_mul_i32 s15, s14, 1152
    s_mov_b32 s64, s16
    s_and_b32 s65, s17, 0xffff
    s_mov_b32 s66, 9216
    s_mov_b32 s67, 0x20000
    s_mov_b32 s56, s28
    s_and_b32 s57, s29, 0xffff
    s_mov_b32 s58, 1152
    s_mov_b32 s59, 0x20000
    v_mov_b32 v40, 0
    v_mov_b32 v41, 0
    s_mov_b32 exec_hi, 0xffff
    v_lshlrev_b32 v8, 3, v1
    buffer_load_dwordx2 v[112:113], v8, s[64:67], s15 offen offset:0
    buffer_load_dwordx2 v[114:115], v8, s[64:67], s15 offen offset:384
    buffer_load_dwordx2 v[116:117], v8, s[64:67], s15 offen offset:768
    buffer_load_dwordx2 v[118:119], v8, s[56:59], 0 offen offset:0
    buffer_load_dwordx2 v[120:121], v8, s[56:59], 0 offen offset:384
    buffer_load_dwordx2 v[122:123], v8, s[56:59], 0 offen offset:768
    s_mul_i32 s68, s14, 2304
    s_add_u32 s68, s68, 1310720
    s_add_u32 s69, s68, 18432
    s_add_u32 s70, s68, 36864
    s_add_u32 s71, s68, 55296
    s_add_u32 s72, s68, 73728
    s_add_u32 s73, s68, 92160
    s_add_u32 s74, s68, 110592
    s_add_u32 s75, s68, 129024
    s_add_u32 s15, s15, s13
    s_add_u32 s15, s15, 1572864
    s_mov_b32 s12, 0x3f803f80
    s_waitcnt vmcnt(0)
    v_lshlrev_b32 v132, 16, v112
    v_and_b32 v133, s76, v112
    v_lshlrev_b32 v134, 16, v113
    v_and_b32 v135, s76, v113
    v_lshlrev_b32 v136, 16, v114
    v_and_b32 v137, s76, v114
    v_lshlrev_b32 v138, 16, v115
    v_and_b32 v139, s76, v115
    v_lshlrev_b32 v140, 16, v116
    v_and_b32 v141, s76, v116
    v_lshlrev_b32 v142, 16, v117
    v_and_b32 v143, s76, v117
    s_add_u32 s12, s26, 0x9e3779b9
    s_cmp_eq_u32 s3, 0
    s_cselect_b32 s12, s26, s12
    s_lshl_b32 s77, s4, 7
    s_add_u32 s77, s77, 2428928
    s_mov_b32 s65, 0
    s_mov_b32 s66, 0
L_shp:
    s_load_dwordx8 s[56:63], s[40:41], s77 glc
    s_waitcnt lgkmcnt(0)
    s_mov_b32 s65, 0
    s_cmp_eq_u32 s63, s12
    s_addc_u32 s65, s65, s65
    s_cmp_eq_u32 s62, s12
    s_addc_u32 s65, s65, s65
    s_cmp_eq_u32 s61, s12
    s_addc_u32 s65, s65, s65
    s_cmp_eq_u32 s60, s12
    s_addc_u32 s65, s65, s65
    s_cmp_eq_u32 s59, s12
    s_addc_u32 s65, s65, s65
    s_cmp_eq_u32 s58, s12
    s_addc_u32 s65, s65, s65
    s_cmp_eq_u32 s57, s12
    s_addc_u32 s65, s65, s65
    s_cmp_eq_u32 s56, s12
    s_addc_u32 s65, s65, s65
    s_cmp_eq_u32 s65, 0xff
    s_cbranch_scc1 L_shd
    s_sleep 2
    s_sub_u32 s42, s42, 1
    s_cbranch_scc0 L_shp
    s_branch L_abort
L_shd:
    s_sleep 3
L_rrp:
    buffer_load_dwordx4 v[144:147], v6, s[44:47], s68 offen offset:0 sc1
    buffer_load_dwordx4 v[148:151], v6, s[44:47], s68 offen offset:768 sc1
    buffer_load_dwordx4 v[152:155], v6, s[44:47], s68 offen offset:1536 sc1
    buffer_load_dwordx4 v[156:159], v6, s[44:47], s69 offen offset:0 sc1
    buffer_load_dwordx4 v[160:163], v6, s[44:47], s69 offen offset:768 sc1
    buffer_load_dwordx4 v[164:167], v6, s[44:47], s69 offen offset:1536 sc1
    buffer_load_dwordx4 v[168:171], v6, s[44:47], s70 offen offset:0 sc1
    buffer_load_dwordx4 v[172:175], v6, s[44:47], s70 offen offset:768 sc1
    buffer_load_dwordx4 v[176:179], v6, s[44:47], s70 offen offset:1536 sc1
    buffer_load_dwordx4 v[180:183], v6, s[44:47], s71 offen offset:0 sc1
    buffer_load_dwordx4 v[184:187], v6, s[44:47], s71 offen offset:768 sc1
    buffer_load_dwordx4 v[188:191], v6, s[44:47], s71 offen offset:1536 sc1
    buffer_load_dwordx4 v[192:195], v6, s[44:47], s72 offen offset:0 sc1
    buffer_load_dwordx4 v[196:199], v6, s[44:47], s72 offen offset:768 sc1
    buffer_load_dwordx4 v[200:203], v6, s[44:47], s72 offen offset:1536 sc1
    buffer_load_dwordx4 v[204:207], v6, s[44:47], s73 offen offset:0 sc1
    buffer_load_dwordx4 v[208:211], v6, s[44:47], s73 offen offset:768 sc1
    buffer_load_dwordx4 v[212:215], v6, s[44:47], s73 offen offset:1536 sc1
    buffer_load_dwordx4 v[216:219], v6, s[44:47], s74 offen offset:0 sc1
    buffer_load_dwordx4 v[220:223], v6, s[44:47], s74 offen offset:768 sc1
    buffer_load_dwordx4 v[224:227], v6, s[44:47], s74 offen offset:1536 sc1
    buffer_load_dwordx4 v[228:231], v6, s[44:47], s75 offen offset:0 sc1
    buffer_load_dwordx4 v[232:235], v6, s[44:47], s75 offen offset:768 sc1
    buffer_load_dwordx4 v[236:239], v6, s[44:47], s75 offen offset:1536 sc1
L_rrc:
    s_waitcnt vmcnt(23)
    v_max3_u32 v124, v144, v145, 0
    v_max3_u32 v124, v146, v147, v124
    s_waitcnt vmcnt(22)
    v_max3_u32 v124, v148, v149, v124
    v_max3_u32 v124, v150, v151, v124
    s_waitcnt vmcnt(21)
    v_max3_u32 v124, v152, v153, v124
    v_max3_u32 v124, v154, v155, v124
    s_waitcnt vmcnt(20)
    v_max3_u32 v124, v156, v157, v124
    v_max3_u32 v124, v158, v159, v124
    v_pk_add_f32 v[144:145], v[144:145], v[156:157]
    v_pk_add_f32 v[146:147], v[146:147], v[158:159]
    s_waitcnt vmcnt(19)
    v_max3_u32 v124, v160, v161, v124
    v_max3_u32 v124, v162, v163, v124
    v_pk_add_f32 v[148:149], v[148:149], v[160:161]
    v_pk_add_f32 v[150:151], v[150:151], v[162:163]
    s_waitcnt vmcnt(18)
    v_max3_u32 v124, v164, v165, v124
    v_max3_u32 v124, v166, v167, v124
    v_pk_add_f32 v[152:153], v[152:153], v[164:165]
    v_pk_add_f32 v[154:155], v[154:155], v[166:167]
    s_waitcnt vmcnt(17)
    v_max3_u32 v124, v168, v169, v124
    v_max3_u32 v124, v170, v171, v124
    v_pk_add_f32 v[144:145], v[144:145], v[168:169]
    v_pk_add_f32 v[146:147], v[146:147], v[170:171]
    s_waitcnt vmcnt(16)
    v_max3_u32 v124, v172, v173, v124
    v_max3_u32 v124, v174, v175, v124
    v_pk_add_f32 v[148:149], v[148:149], v[172:173]
    v_pk_add_f32 v[150:151], v[150:151], v[174:175]
    s_waitcnt vmcnt(15)
    v_max3_u32 v124, v176, v177, v124
    v_max3_u32 v124, v178, v179, v124
    v_pk_add_f32 v[152:153], v[152:153], v[176:177]
    v_pk_add_f32 v[154:155], v[154:155], v[178:179]
    s_waitcnt vmcnt(14)
    v_max3_u32 v124, v180, v181, v124
    v_max3_u32 v124, v182, v183, v124
    v_pk_add_f32 v[144:145], v[144:145], v[180:181]
    v_pk_add_f32 v[146:147], v[146:147], v[182:183]
    s_waitcnt vmcnt(13)
    v_max3_u32 v124, v184, v185, v124
    v_max3_u32 v124, v186, v187, v124
    v_pk_add_f32 v[148:149], v[148:149], v[184:185]
    v_pk_add_f32 v[150:151], v[150:151], v[186:187]
    s_waitcnt vmcnt(12)
    v_max3_u32 v124, v188, v189, v124
    v_max3_u32 v124, v190, v191, v124
    v_pk_add_f32 v[152:153], v[152:153], v[188:189]
    v_pk_add_f32 v[154:155], v[154:155], v[190:191]
    s_waitcnt vmcnt(11)
    v_max3_u32 v124, v192, v193, v124
    v_max3_u32 v124, v194, v195, v124
    v_pk_add_f32 v[144:145], v[144:145], v[192:193]
    v_pk_add_f32 v[146:147], v[146:147], v[194:195]
    s_waitcnt vmcnt(10)
    v_max3_u32 v124, v196, v197, v124
    v_max3_u32 v124, v198, v199, v124
    v_pk_add_f32 v[148:149], v[148:149], v[196:197]
    v_pk_add_f32 v[150:151], v[150:151], v[198:199]
    s_waitcnt vmcnt(9)
    v_max3_u32 v124, v200, v201, v124
    v_max3_u32 v124, v202, v203, v124
    v_pk_add_f32 v[152:153], v[152:153], v[200:201]
    v_pk_add_f32 v[154:155], v[154:155], v[202:203]
    s_waitcnt vmcnt(8)
    v_max3_u32 v124, v204, v205, v124
    v_max3_u32 v124, v206, v207, v124
    v_pk_add_f32 v[144:145], v[144:145], v[204:205]
    v_pk_add_f32 v[146:147], v[146:147], v[206:207]
    s_waitcnt vmcnt(7)
    v_max3_u32 v124, v208, v209, v124
    v_max3_u32 v124, v210, v211, v124
    v_pk_add_f32 v[148:149], v[148:149], v[208:209]
    v_pk_add_f32 v[150:151], v[150:151], v[210:211]
    s_waitcnt vmcnt(6)
    v_max3_u32 v124, v212, v213, v124
    v_max3_u32 v124, v214, v215, v124
    v_pk_add_f32 v[152:153], v[152:153], v[212:213]
    v_pk_add_f32 v[154:155], v[154:155], v[214:215]
    s_waitcnt vmcnt(5)
    v_max3_u32 v124, v216, v217, v124
    v_max3_u32 v124, v218, v219, v124
    v_pk_add_f32 v[144:145], v[144:145], v[216:217]
    v_pk_add_f32 v[146:147], v[146:147], v[218:219]
    s_waitcnt vmcnt(4)
    v_max3_u32 v124, v220, v221, v124
    v_max3_u32 v124, v222, v223, v124
    v_pk_add_f32 v[148:149], v[148:149], v[220:221]
    v_pk_add_f32 v[150:151], v[150:151], v[222:223]
    s_waitcnt vmcnt(3)
    v_max3_u32 v124, v224, v225, v124
    v_max3_u32 v124, v226, v227, v124
    v_pk_add_f32 v[152:153], v[152:153], v[224:225]
    v_pk_add_f32 v[154:155], v[154:155], v[226:227]
    s_waitcnt vmcnt(2)
    v_max3_u32 v124, v228, v229, v124
    v_max3_u32 v124, v230, v231, v124
    v_pk_add_f32 v[144:145], v[144:145], v[228:229]
    v_pk_add_f32 v[146:147], v[146:147], v[230:231]
    s_waitcnt vmcnt(1)
    v_max3_u32 v124, v232, v233, v124
    v_max3_u32 v124, v234, v235, v124
    v_pk_add_f32 v[148:149], v[148:149], v[232:233]
    v_pk_add_f32 v[150:151], v[150:151], v[234:235]
    s_waitcnt vmcnt(0)
    v_max3_u32 v124, v236, v237, v124
    v_max3_u32 v124, v238, v239, v124
    v_pk_add_f32 v[152:153], v[152:153], v[236:237]
    v_pk_add_f32 v[154:155], v[154:155], v[238:239]
    v_cmp_eq_u32 vcc, -1, v124
    s_cbranch_vccz L_rrd
    s_sub_u32 s42, s42, 1
    s_cbranch_scc0 L_rrp
    s_branch L_abort
L_rrd:
    v_cvt_pk_bf16_f32 v126, v144, v145
    v_cvt_pk_bf16_f32 v127, v146, v147
    v_cvt_pk_bf16_f32 v128, v148, v149
    v_cvt_pk_bf16_f32 v129, v150, v151
    v_cvt_pk_bf16_f32 v130, v152, v153
    v_cvt_pk_bf16_f32 v131, v154, v155
    v_lshlrev_b32 v16, 16, v126
    v_and_b32 v17, s76, v126
    v_lshlrev_b32 v18, 16, v127
    v_and_b32 v19, s76, v127
    v_lshlrev_b32 v20, 16, v128
    v_and_b32 v21, s76, v128
    v_lshlrev_b32 v22, 16, v129
    v_and_b32 v23, s76, v129
    v_lshlrev_b32 v24, 16, v130
    v_and_b32 v25, s76, v130
    v_lshlrev_b32 v26, 16, v131
    v_and_b32 v27, s76, v131
    v_pk_add_f32 v[16:17], v[16:17], v[132:133]
    v_pk_add_f32 v[18:19], v[18:19], v[134:135]
    v_pk_add_f32 v[20:21], v[20:21], v[136:137]
    v_pk_add_f32 v[22:23], v[22:23], v[138:139]
    v_pk_add_f32 v[24:25], v[24:25], v[140:141]
    v_pk_add_f32 v[26:27], v[26:27], v[142:143]
    v_cvt_pk_bf16_f32 v126, v16, v17
    v_cvt_pk_bf16_f32 v127, v18, v19
    v_cvt_pk_bf16_f32 v128, v20, v21
    v_cvt_pk_bf16_f32 v129, v22, v23
    v_cvt_pk_bf16_f32 v130, v24, v25
    v_cvt_pk_bf16_f32 v131, v26, v27
    v_lshlrev_b32 v28, 16, v126
    v_and_b32 v29, s76, v126
    v_lshlrev_b32 v30, 16, v127
    v_and_b32 v31, s76, v127
    v_lshlrev_b32 v32, 16, v128
    v_and_b32 v33, s76, v128
    v_lshlrev_b32 v34, 16, v129
    v_and_b32 v35, s76, v129
    v_lshlrev_b32 v36, 16, v130
    v_and_b32 v37, s76, v130
    v_lshlrev_b32 v38, 16, v131
    v_and_b32 v39, s76, v131
    v_pk_add_f32 v[44:45], v[28:29], v[30:31]
    v_pk_mul_f32 v[46:47], v[28:29], v[28:29]
    v_pk_fma_f32 v[46:47], v[30:31], v[30:31], v[46:47]
    v_pk_add_f32 v[44:45], v[44:45], v[32:33]
    v_pk_fma_f32 v[46:47], v[32:33], v[32:33], v[46:47]
    v_pk_add_f32 v[44:45], v[44:45], v[34:35]
    v_pk_fma_f32 v[46:47], v[34:35], v[34:35], v[46:47]
    v_pk_add_f32 v[44:45], v[44:45], v[36:37]
    v_pk_fma_f32 v[46:47], v[36:37], v[36:37], v[46:47]
    v_pk_add_f32 v[44:45], v[44:45], v[38:39]
    v_pk_fma_f32 v[46:47], v[38:39], v[38:39], v[46:47]
    v_add_f32 v40, v44, v45
    v_add_f32 v41, v46, v47
    s_mov_b64 exec, -1
    v_add_f32_dpp v40, v40, v40 quad_perm:[1,0,3,2] row_mask:0xf bank_mask:0xf
    v_add_f32_dpp v41, v41, v41 quad_perm:[1,0,3,2] row_mask:0xf bank_mask:0xf
    s_nop 0
    v_add_f32_dpp v40, v40, v40 quad_perm:[2,3,0,1] row_mask:0xf bank_mask:0xf
    v_add_f32_dpp v41, v41, v41 quad_perm:[2,3,0,1] row_mask:0xf bank_mask:0xf
    s_nop 0
    v_add_f32_dpp v40, v40, v40 row_half_mirror row_mask:0xf bank_mask:0xf
    v_add_f32_dpp v41, v41, v41 row_half_mirror row_mask:0xf bank_mask:0xf
    s_nop 0
    v_add_f32_dpp v40, v40, v40 row_mirror row_mask:0xf bank_mask:0xf
    v_add_f32_dpp v41, v41, v41 row_mirror row_mask:0xf bank_mask:0xf
    v_mov_b32 v42, v40
    v_mov_b32 v43, v41
    s_nop 0
    v_permlane16_swap_b32 v40, v42
    v_permlane16_swap_b32 v41, v43
    v_add_f32 v40, v40, v42
    v_add_f32 v41, v41, v43
    v_mov_b32 v42, v40
    v_mov_b32 v43, v41
    s_nop 0
    v_permlane32_swap_b32 v40, v42
    v_permlane32_swap_b32 v41, v43
    v_add_f32 v40, v40, v42
    v_add_f32 v41, v41, v43
    v_mul_f32 v55, 0xbae38e39, v40
    v_mul_f32 v54, 0x3ae38e39, v41
    v_fma_f32 v54, -v55, v55, v54
    v_max_f32 v54, 0, v54
    v_cvt_pk_bf16_f32 v54, v54, v55
    v_and_b32 v50, s76, v54
    v_lshlrev_b32 v54, 16, v54
    v_add_f32 v54, 0x3727c5ac, v54
    v_cvt_pk_bf16_f32 v54, v54, v54
    v_and_b32 v54, s76, v54
    v_sqrt_f32 v54, v54
    v_mov_b32 v51, v50
    v_cvt_pk_bf16_f32 v54, v54, v54
    v_and_b32 v54, s76, v54
    v_rcp_f32 v52, v54
    v_rcp_f32 v53, v54
    s_mov_b32 exec_hi, 0xffff
    v_pk_add_f32 v[28:29], v[28:29], v[50:51]
    v_pk_add_f32 v[30:31], v[30:31], v[50:51]
    v_pk_add_f32 v[32:33], v[32:33], v[50:51]
    v_pk_add_f32 v[34:35], v[34:35], v[50:51]
    v_pk_add_f32 v[36:37], v[36:37], v[50:51]
    v_pk_add_f32 v[38:39], v[38:39], v[50:51]
    v_cvt_pk_bf16_f32 v56, v28, v29
    v_cvt_pk_bf16_f32 v57, v30, v31
    v_cvt_pk_bf16_f32 v58, v32, v33
    v_cvt_pk_bf16_f32 v59, v34, v35
    v_cvt_pk_bf16_f32 v60, v36, v37
    v_cvt_pk_bf16_f32 v61, v38, v39
    v_lshlrev_b32 v28, 16, v56
    v_and_b32 v29, s76, v56
    v_lshlrev_b32 v30, 16, v57
    v_and_b32 v31, s76, v57
    v_lshlrev_b32 v32, 16, v58
    v_and_b32 v33, s76, v58
    v_lshlrev_b32 v34, 16, v59
    v_and_b32 v35, s76, v59
    v_lshlrev_b32 v36, 16, v60
    v_and_b32 v37, s76, v60
    v_lshlrev_b32 v38, 16, v61
    v_and_b32 v39, s76, v61
    v_pk_mul_f32 v[28:29], v[28:29], v[52:53]
    v_pk_mul_f32 v[30:31], v[30:31], v[52:53]
    v_pk_mul_f32 v[32:33], v[32:33], v[52:53]
    v_pk_mul_f32 v[34:35], v[34:35], v[52:53]
    v_pk_mul_f32 v[36:37], v[36:37], v[52:53]
    v_pk_mul_f32 v[38:39], v[38:39], v[52:53]
    v_cvt_pk_bf16_f32 v56, v28, v29
    v_cvt_pk_bf16_f32 v57, v30, v31
    v_cvt_pk_bf16_f32 v58, v32, v33
    v_cvt_pk_bf16_f32 v59, v34, v35
    v_cvt_pk_bf16_f32 v60, v36, v37
    v_cvt_pk_bf16_f32 v61, v38, v39
    v_min_u32 v56, -2, v56
    v_min_u32 v57, -2, v57
    v_min_u32 v58, -2, v58
    v_min_u32 v59, -2, v59
    v_min_u32 v60, -2, v60
    v_min_u32 v61, -2, v61
    s_cmp_eq_u32 s43, 1
    s_cbranch_scc0 Lps_23
    buffer_store_dwordx2 v[56:57], v8, s[44:47], s15 offen offset:0
    buffer_store_dwordx2 v[58:59], v8, s[44:47], s15 offen offset:384
    buffer_store_dwordx2 v[60:61], v8, s[44:47], s15 offen offset:768
    s_branch Lpe_24
Lps_23:
    buffer_store_dwordx2 v[56:57], v8, s[44:47], s15 offen offset:0 sc1
    buffer_store_dwordx2 v[58:59], v8, s[44:47], s15 offen offset:384 sc1
    buffer_store_dwordx2 v[60:61], v8, s[44:47], s15 offen offset:768 sc1
Lpe_24:
    v_min_u32 v126, -2, v126
    v_min_u32 v127, -2, v127
    v_min_u32 v128, -2, v128
    v_min_u32 v129, -2, v129
    v_min_u32 v130, -2, v130
    v_min_u32 v131, -2, v131
    s_add_u32 s15, s15, 9216
    s_cmp_eq_u32 s43, 1
    s_cbranch_scc0 Lps_25
    buffer_store_dwordx2 v[126:127], v8, s[44:47], s15 offen offset:0
    buffer_store_dwordx2 v[128:129], v8, s[44:47], s15 offen offset:384
    buffer_store_dwordx2 v[130:131], v8, s[44:47], s15 offen offset:768
    s_branch Lpe_26
Lps_25:
    buffer_store_dwordx2 v[126:127], v8, s[44:47], s15 offen offset:0 sc1
    buffer_store_dwordx2 v[128:129], v8, s[44:47], s15 offen offset:384 sc1
    buffer_store_dwordx2 v[130:131], v8, s[44:47], s15 offen offset:768 sc1
Lpe_26:
    s_mov_b64 exec, -1
    v_mov_b32 v40, 0
    s_mov_b32 exec_hi, 0xffff
    v_dot2_f32_bf16 v40, v56, v118, v40
    v_dot2_f32_bf16 v40, v57, v119, v40
    v_dot2_f32_bf16 v40, v58, v120, v40
    v_dot2_f32_bf16 v40, v59, v121, v40
    v_dot2_f32_bf16 v40, v60, v122, v40
    v_dot2_f32_bf16 v40, v61, v123, v40
    s_mov_b64 exec, -1
    s_nop 1
    v_add_f32_dpp v40, v40, v40 quad_perm:[1,0,3,2] row_mask:0xf bank_mask:0xf
    s_nop 1
    v_add_f32_dpp v40, v40, v40 quad_perm:[2,3,0,1] row_mask:0xf bank_mask:0xf
    s_nop 1
    v_add_f32_dpp v40, v40, v40 row_half_mirror row_mask:0xf bank_mask:0xf
    s_nop 1
    v_add_f32_dpp v40, v40, v40 row_mirror row_mask:0xf bank_mask:0xf
    v_mov_b32 v42, v40
    s_nop 1
    v_permlane16_swap_b32 v40, v42
    v_add_f32 v40, v40, v42
    v_mov_b32 v42, v40
    s_nop 1
    v_permlane32_swap_b32 v40, v42
    v_add_f32 v40, v40, v42
    v_cvt_pk_bf16_f32 v40, v40, v40
    v_and_b32 v40, s76, v40
    v_mul_f32 v40, 0xbfb8aa3b, v40
    v_exp_f32 v40, v40
    s_nop 0
    v_add_f32 v40, 1.0, v40
    v_rcp_f32 v40, v40
    s_nop 0
    v_cvt_pk_bf16_f32 v40, v40, v40
    v_and_b32 v40, s76, v40
    s_lshl_b32 s14, s14, 4
    s_add_u32 s14, s14, s13
    s_add_u32 s14, s14, 1591296
    s_mov_b64 exec, 1
    s_cmp_eq_u32 s43, 1
    s_cbranch_scc0 Lps_27
    buffer_store_dword v40, v2, s[44:47], s14 offen offset:0
    s_branch Lpe_28
Lps_27:
    buffer_store_dword v40, v2, s[44:47], s14 offen offset:0 sc1
Lpe_28:
    s_branch L_fin
L_ffn1:
    s_lshl_b32 s11, s12, 10
    s_add_u32 s14, s13, s11
    s_add_u32 s14, s14, 1572864
    s_add_u32 s70, s14, 4096
    s_add_u32 s15, s13, 1581056
    s_mov_b32 s71, 0x38e38e4
    s_lshl_b32 s11, s12, 6
    v_add_u32 v13, s11, v1
    v_add_u32 v15, 256, v13
    v_add_u32 v10, 512, v1
    v_mul_hi_u32 v11, v13, s71
    v_lshlrev_b32 v13, 4, v13
    v_lshl_add_u32 v13, v11, 5, v13
    v_mul_hi_u32 v11, v15, s71
    v_lshlrev_b32 v15, 4, v15
    v_lshl_add_u32 v15, v11, 5, v15
    v_mul_hi_u32 v11, v10, s71
    v_lshlrev_b32 v10, 4, v10
    v_lshl_add_u32 v10, v11, 5, v10
    v_and_b32 v7, 7, v1
    v_mul_u32_u24 v7, 1184, v7
    v_bfe_u32 v11, v1, 3, 1
    v_lshl_add_u32 v7, v11, 6, v7
    v_lshrrev_b32 v11, 4, v1
    v_lshl_add_u32 v7, v11, 4, v7
    v_and_b32 v14, 15, v1
    v_mul_u32_u24 v14, 32, v14
    v_lshrrev_b32 v11, 4, v1
    v_mul_u32_u24 v11, 8, v11
    v_add_u32 v14, v14, v11
    s_cmp_ge_u32 s5, 9
    s_cselect_b32 s74, 9, 0
    s_cselect_b32 s11, 9216, 0
    s_sub_u32 s74, s5, s74
    s_lshl_b32 s74, s74, 10
    s_add_u32 s74, s74, s11
    s_add_u32 s74, s74, s13
    s_lshl_b32 s11, s12, 8
    s_add_u32 s74, s74, s11
    s_add_u32 s74, s74, 1835008
    v_lshrrev_b32 v11, 4, v1
    v_bfe_u32 v12, v1, 2, 2
    v_lshl_add_u32 v8, v11, 3, v12
    v_lshlrev_b32 v8, 7, v8
    v_and_b32 v11, 1, v11
    v_lshlrev_b32 v11, 6, v11
    v_and_b32 v12, 2, v12
    v_lshl_add_u32 v11, v12, 4, v11
    v_and_b32 v12, 3, v1
    v_lshlrev_b32 v12, 3, v12
    v_xor_b32 v11, v11, v12
    v_add_u32 v8, v8, v11
    s_lshl_b32 s11, s12, 5
    v_xor_b32 v8, s11, v8
    v_add_u32 v8, 24576, v8
    v_add_u32 v9, 0x8000, v8
    s_mov_b32 s77, 0
Lfw_29:
    ds_read_b32 v4, v2 offset:16
    s_waitcnt lgkmcnt(0)
    v_readfirstlane_b32 s11, v4
    s_nop 0
    s_cmp_ge_u32 s11, 1
    s_cbranch_scc1 Lfd_30
    s_sleep 2
    s_sub_u32 s42, s42, 1
    s_cbranch_scc0 Lfw_29
    s_branch L_abort
Lfd_30:
L_f1_p:
    buffer_load_dwordx4 v[88:91], v6, s[44:47], s14 offen offset:0 sc1
    buffer_load_dwordx4 v[92:95], v6, s[44:47], s70 offen offset:0 sc1
    buffer_load_dwordx4 v[96:99], v6, s[44:47], s15 offen offset:0 sc1
    s_cmp_eq_u32 s77, 1
    s_cbranch_scc1 L_f1_c
    ds_read_b32 v4, v2 offset:16
    s_waitcnt lgkmcnt(0)
    v_readfirstlane_b32 s11, v4
    s_nop 0
    s_cmp_lt_u32 s11, 3
    s_cbranch_scc1 L_f1_c
    ds_read_b64_tr_b16 v[16:17], v8 offset:0
    ds_read_b64_tr_b16 v[18:19], v8 offset:512
    ds_read_b64_tr_b16 v[20:21], v8 offset:4096
    ds_read_b64_tr_b16 v[22:23], v8 offset:4608
    ds_read_b64_tr_b16 v[24:25], v8 offset:8192
    ds_read_b64_tr_b16 v[26:27], v8 offset:8704
    ds_read_b64_tr_b16 v[28:29], v8 offset:12288
    ds_read_b64_tr_b16 v[30:31], v8 offset:12800
    ds_read_b64_tr_b16 v[32:33], v8 offset:16384
    ds_read_b64_tr_b16 v[34:35], v8 offset:16896
    ds_read_b64_tr_b16 v[36:37], v8 offset:20480
    ds_read_b64_tr_b16 v[38:39], v8 offset:20992
    ds_read_b64_tr_b16 v[40:41], v8 offset:24576
    ds_read_b64_tr_b16 v[42:43], v8 offset:25088
    ds_read_b64_tr_b16 v[44:45], v8 offset:28672
    ds_read_b64_tr_b16 v[46:47], v8 offset:29184
    ds_read_b64_tr_b16 v[48:49], v9 offset:0
    ds_read_b64_tr_b16 v[50:51], v9 offset:512
    ds_read_b64_tr_b16 v[52:53], v9 offset:4096
    ds_read_b64_tr_b16 v[54:55], v9 offset:4608
    ds_read_b64_tr_b16 v[56:57], v9 offset:8192
    ds_read_b64_tr_b16 v[58:59], v9 offset:8704
    ds_read_b64_tr_b16 v[60:61], v9 offset:12288
    ds_read_b64_tr_b16 v[62:63], v9 offset:12800
    ds_read_b64_tr_b16 v[64:65], v9 offset:16384
    ds_read_b64_tr_b16 v[66:67], v9 offset:16896
    ds_read_b64_tr_b16 v[68:69], v9 offset:20480
    ds_read_b64_tr_b16 v[70:71], v9 offset:20992
    ds_read_b64_tr_b16 v[72:73], v9 offset:24576
    ds_read_b64_tr_b16 v[74:75], v9 offset:25088
    ds_read_b64_tr_b16 v[76:77], v9 offset:28672
    ds_read_b64_tr_b16 v[78:79], v9 offset:29184
    ds_read_b64_tr_b16 v[80:81], v9 offset:32768
    ds_read_b64_tr_b16 v[82:83], v9 offset:33280
    ds_read_b64_tr_b16 v[84:85], v9 offset:36864
    ds_read_b64_tr_b16 v[86:87], v9 offset:37376
    s_mov_b32 s77, 1
L_f1_c:
    s_waitcnt vmcnt(2)
    v_max3_u32 v124, v88, v89, 0
    v_max3_u32 v124, v90, v91, v124
    s_waitcnt vmcnt(1)
    v_max3_u32 v124, v92, v93, v124
    v_max3_u32 v124, v94, v95, v124
    s_waitcnt vmcnt(0)
    v_max3_u32 v124, v96, v97, v124
    v_max3_u32 v124, v98, v99, v124
    v_cmp_eq_u32 vcc, -1, v124
    s_cbranch_vccz L_f1_g
    s_sub_u32 s42, s42, 1
    s_cbranch_scc0 L_f1_p
    s_branch L_abort
L_f1_g:
    ds_write_b128 v13, v[88:91] offset:12288
    ds_write_b128 v15, v[92:95] offset:12288
    ds_write_b128 v10, v[96:99] offset:12288
    s_waitcnt lgkmcnt(0)
    s_barrier
    s_cmp_eq_u32 s77, 1
    s_cbranch_scc1 L_f1_m
    ds_read_b128 v[128:131], v7 offset:12288
    ds_read_b64_tr_b16 v[16:17], v8 offset:0
    ds_read_b64_tr_b16 v[18:19], v8 offset:512
    ds_read_b64_tr_b16 v[20:21], v8 offset:4096
    ds_read_b64_tr_b16 v[22:23], v8 offset:4608
    ds_read_b128 v[132:135], v7 offset:12416
    ds_read_b64_tr_b16 v[24:25], v8 offset:8192
    ds_read_b64_tr_b16 v[26:27], v8 offset:8704
    ds_read_b64_tr_b16 v[28:29], v8 offset:12288
    ds_read_b64_tr_b16 v[30:31], v8 offset:12800
    ds_read_b128 v[136:139], v7 offset:12544
    ds_read_b64_tr_b16 v[32:33], v8 offset:16384
    ds_read_b64_tr_b16 v[34:35], v8 offset:16896
    ds_read_b64_tr_b16 v[36:37], v8 offset:20480
    ds_read_b64_tr_b16 v[38:39], v8 offset:20992
    s_waitcnt lgkmcnt(10)
    v_mfma_f32_16x16x32_bf16 v[112:115], v[16:19], v[128:131], 0
    v_mfma_f32_16x16x32_bf16 v[116:119], v[20:23], v[128:131], 0
    ds_read_b128 v[140:143], v7 offset:12672
    ds_read_b64_tr_b16 v[40:41], v8 offset:24576
    ds_read_b64_tr_b16 v[42:43], v8 offset:25088
    ds_read_b64_tr_b16 v[44:45], v8 offset:28672
    ds_read_b64_tr_b16 v[46:47], v8 offset:29184
    s_waitcnt lgkmcnt(10)
    v_mfma_f32_16x16x32_bf16 v[112:115], v[24:27], v[132:135], v[112:115]
    v_mfma_f32_16x16x32_bf16 v[116:119], v[28:31], v[132:135], v[116:119]
    ds_read_b128 v[144:147], v7 offset:12800
    ds_read_b64_tr_b16 v[48:49], v9 offset:0
    ds_read_b64_tr_b16 v[50:51], v9 offset:512
    ds_read_b64_tr_b16 v[52:53], v9 offset:4096
    ds_read_b64_tr_b16 v[54:55], v9 offset:4608
    s_waitcnt lgkmcnt(10)
    v_mfma_f32_16x16x32_bf16 v[112:115], v[32:35], v[136:139], v[112:115]
    v_mfma_f32_16x16x32_bf16 v[116:119], v[36:39], v[136:139], v[116:119]
    ds_read_b128 v[148:151], v7 offset:12928
    ds_read_b64_tr_b16 v[56:57], v9 offset:8192
    ds_read_b64_tr_b16 v[58:59], v9 offset:8704
    ds_read_b64_tr_b16 v[60:61], v9 offset:12288
    ds_read_b64_tr_b16 v[62:63], v9 offset:12800
    s_waitcnt lgkmcnt(10)
    v_mfma_f32_16x16x32_bf16 v[112:115], v[40:43], v[140:143], v[112:115]
    v_mfma_f32_16x16x32_bf16 v[116:119], v[44:47], v[140:143], v[116:119]
    ds_read_b128 v[152:155], v7 offset:13056
    ds_read_b64_tr_b16 v[64:65], v9 offset:16384
    ds_read_b64_tr_b16 v[66:67], v9 offset:16896
    ds_read_b64_tr_b16 v[68:69], v9 offset:20480
    ds_read_b64_tr_b16 v[70:71], v9 offset:20992
    s_waitcnt lgkmcnt(10)
    v_mfma_f32_16x16x32_bf16 v[112:115], v[48:51], v[144:147], v[112:115]
    v_mfma_f32_16x16x32_bf16 v[116:119], v[52:55], v[144:147], v[116:119]
    ds_read_b128 v[156:159], v7 offset:13184
    ds_read_b64_tr_b16 v[72:73], v9 offset:24576
    ds_read_b64_tr_b16 v[74:75], v9 offset:25088
    ds_read_b64_tr_b16 v[76:77], v9 offset:28672
    ds_read_b64_tr_b16 v[78:79], v9 offset:29184
    s_waitcnt lgkmcnt(10)
    v_mfma_f32_16x16x32_bf16 v[112:115], v[56:59], v[148:151], v[112:115]
    v_mfma_f32_16x16x32_bf16 v[116:119], v[60:63], v[148:151], v[116:119]
    ds_read_b128 v[160:163], v7 offset:13312
    ds_read_b64_tr_b16 v[80:81], v9 offset:32768
    ds_read_b64_tr_b16 v[82:83], v9 offset:33280
    ds_read_b64_tr_b16 v[84:85], v9 offset:36864
    ds_read_b64_tr_b16 v[86:87], v9 offset:37376
    s_waitcnt lgkmcnt(10)
    v_mfma_f32_16x16x32_bf16 v[112:115], v[64:67], v[152:155], v[112:115]
    v_mfma_f32_16x16x32_bf16 v[116:119], v[68:71], v[152:155], v[116:119]
    s_waitcnt lgkmcnt(5)
    v_mfma_f32_16x16x32_bf16 v[112:115], v[72:75], v[156:159], v[112:115]
    v_mfma_f32_16x16x32_bf16 v[116:119], v[76:79], v[156:159], v[116:119]
    s_waitcnt lgkmcnt(0)
    v_mfma_f32_16x16x32_bf16 v[112:115], v[80:83], v[160:163], v[112:115]
    v_mfma_f32_16x16x32_bf16 v[116:119], v[84:87], v[160:163], v[116:119]
    s_branch L_f1_s
L_f1_m:
    ds_read_b128 v[128:131], v7 offset:12288
    ds_read_b128 v[132:135], v7 offset:12416
    ds_read_b128 v[136:139], v7 offset:12544
    ds_read_b128 v[140:143], v7 offset:12672
    ds_read_b128 v[144:147], v7 offset:12800
    ds_read_b128 v[148:151], v7 offset:12928
    ds_read_b128 v[152:155], v7 offset:13056
    ds_read_b128 v[156:159], v7 offset:13184
    ds_read_b128 v[160:163], v7 offset:13312
    s_waitcnt lgkmcnt(8)
    v_mfma_f32_16x16x32_bf16 v[112:115], v[16:19], v[128:131], 0
    v_mfma_f32_16x16x32_bf16 v[116:119], v[20:23], v[128:131], 0
    s_waitcnt lgkmcnt(7)
    v_mfma_f32_16x16x32_bf16 v[112:115], v[24:27], v[132:135], v[112:115]
    v_mfma_f32_16x16x32_bf16 v[116:119], v[28:31], v[132:135], v[116:119]
    s_waitcnt lgkmcnt(6)
    v_mfma_f32_16x16x32_bf16 v[112:115], v[32:35], v[136:139], v[112:115]
    v_mfma_f32_16x16x32_bf16 v[116:119], v[36:39], v[136:139], v[116:119]
    s_waitcnt lgkmcnt(5)
    v_mfma_f32_16x16x32_bf16 v[112:115], v[40:43], v[140:143], v[112:115]
    v_mfma_f32_16x16x32_bf16 v[116:119], v[44:47], v[140:143], v[116:119]
    s_waitcnt lgkmcnt(4)
    v_mfma_f32_16x16x32_bf16 v[112:115], v[48:51], v[144:147], v[112:115]
    v_mfma_f32_16x16x32_bf16 v[116:119], v[52:55], v[144:147], v[116:119]
    s_waitcnt lgkmcnt(3)
    v_mfma_f32_16x16x32_bf16 v[112:115], v[56:59], v[148:151], v[112:115]
    v_mfma_f32_16x16x32_bf16 v[116:119], v[60:63], v[148:151], v[116:119]
    s_waitcnt lgkmcnt(2)
    v_mfma_f32_16x16x32_bf16 v[112:115], v[64:67], v[152:155], v[112:115]
    v_mfma_f32_16x16x32_bf16 v[116:119], v[68:71], v[152:155], v[116:119]
    s_waitcnt lgkmcnt(1)
    v_mfma_f32_16x16x32_bf16 v[112:115], v[72:75], v[156:159], v[112:115]
    v_mfma_f32_16x16x32_bf16 v[116:119], v[76:79], v[156:159], v[116:119]
    s_waitcnt lgkmcnt(0)
    v_mfma_f32_16x16x32_bf16 v[112:115], v[80:83], v[160:163], v[112:115]
    v_mfma_f32_16x16x32_bf16 v[116:119], v[84:87], v[160:163], v[116:119]
L_f1_s:
    s_nop 7
    v_add_f32_dpp v112, v116, v112 row_ror:8 row_mask:0xf bank_mask:0xf
    v_add_f32_dpp v113, v117, v113 row_ror:8 row_mask:0xf bank_mask:0xf
    v_add_f32_dpp v114, v118, v114 row_ror:8 row_mask:0xf bank_mask:0xf
    v_add_f32_dpp v115, v119, v115 row_ror:8 row_mask:0xf bank_mask:0xf
    v_cvt_pk_bf16_f32 v120, v112, v113
    v_cvt_pk_bf16_f32 v121, v114, v115
    s_cmp_ge_u32 s5, 9
    s_cbranch_scc1 L_f1_st
    v_lshlrev_b32 v112, 16, v120
    v_and_b32 v113, s76, v120
    v_lshlrev_b32 v114, 16, v121
    v_and_b32 v115, s76, v121
    v_mul_f32 v116, 0xbfb8aa3b, v112
    v_mul_f32 v117, 0xbfb8aa3b, v113
    v_mul_f32 v118, 0xbfb8aa3b, v114
    v_mul_f32 v119, 0xbfb8aa3b, v115
    v_exp_f32 v116, v116
    v_exp_f32 v117, v117
    v_exp_f32 v118, v118
    v_exp_f32 v119, v119
    v_add_f32 v116, 1.0, v116
    v_add_f32 v117, 1.0, v117
    v_add_f32 v118, 1.0, v118
    v_add_f32 v119, 1.0, v119
    v_rcp_f32 v116, v116
    v_rcp_f32 v117, v117
    v_rcp_f32 v118, v118
    v_rcp_f32 v119, v119
    v_mul_f32 v112, v112, v116
    v_mul_f32 v113, v113, v117
    v_mul_f32 v114, v114, v118
    v_mul_f32 v115, v115, v119
    v_cvt_pk_bf16_f32 v120, v112, v113
    v_cvt_pk_bf16_f32 v121, v114, v115
L_f1_st:
    v_min_u32 v120, -2, v120
    v_min_u32 v121, -2, v121
    s_mov_b32 exec_lo, 0x00ff00ff
    s_mov_b32 exec_hi, 0x00ff00ff
    s_cmp_eq_u32 s43, 1
    s_cbranch_scc0 Lps_31
    buffer_store_dwordx2 v[120:121], v14, s[44:47], s74 offen offset:0
    s_branch Lpe_32
Lps_31:
    buffer_store_dwordx2 v[120:121], v14, s[44:47], s74 offen offset:0 sc1
Lpe_32:
    s_branch L_fin
L_wo:
    s_lshl_b32 s14, s4, 10
    s_lshl_b32 s11, s12, 15
    s_add_u32 s14, s14, s11
    s_add_u32 s68, s14, 2621440
    s_add_u32 s69, s68, 8192
    s_add_u32 s70, s68, 16384
    s_add_u32 s71, s68, 24576
    v_add_u32 v10, 0x20000, v6
    v_and_b32 v7, 7, v1
    v_lshlrev_b32 v7, 4, v7
    v_lshrrev_b32 v11, 4, v1
    v_lshl_add_u32 v7, v11, 7, v7
    v_lshrrev_b32 v13, 3, v1
    v_lshlrev_b32 v13, 9, v13
    v_bfe_u32 v11, v1, 1, 2
    v_lshl_add_u32 v13, v11, 7, v13
    v_and_b32 v11, 1, v1
    v_lshl_add_u32 v13, v11, 3, v13
    s_lshr_b32 s11, s12, 1
    s_lshl_b32 s11, s11, 12
    s_and_b32 s14, s12, 1
    s_lshl_b32 s14, s14, 6
    s_add_u32 s11, s11, s14
    v_add_u32 v13, s11, v13
    v_and_b32 v15, 15, v1
    v_mul_u32_u24 v15, 2304, v15
    v_lshrrev_b32 v11, 4, v1
    v_mul_u32_u24 v11, 16, v11
    v_add_u32 v15, v15, v11
    s_sub_u32 s74, s5, 18
    s_lshl_b32 s74, s74, 8
    s_mul_i32 s11, s4, 18432
    s_add_u32 s74, s74, s11
    s_lshl_b32 s11, s12, 6
    s_add_u32 s74, s74, s11
    s_add_u32 s75, s74, 1310720
    s_add_u32 s74, s74, 2097152
    v_lshrrev_b32 v11, 4, v1
    v_bfe_u32 v12, v1, 2, 2
    v_lshlrev_b32 v8, 1, v11
    v_lshl_add_u32 v8, v12, 3, v8
    v_lshlrev_b32 v8, 7, v8
    v_and_b32 v11, 1, v11
    v_lshlrev_b32 v11, 5, v11
    v_and_b32 v12, 1, v12
    v_lshl_add_u32 v11, v12, 6, v11
    v_and_b32 v12, 3, v1
    v_lshlrev_b32 v12, 3, v12
    v_xor_b32 v11, v11, v12
    v_add_u32 v8, v8, v11
    s_lshl_b32 s11, s12, 5
    v_xor_b32 v8, s11, v8
    v_add_u32 v8, 24576, v8
    v_add_u32 v9, 0x8000, v8
    s_mov_b32 s77, 0
L_wo_p:
    buffer_load_dwordx4 v[80:83], v6, s[44:47], s68 offen offset:0 sc1
    buffer_load_dwordx4 v[84:87], v10, s[44:47], s68 offen offset:0 sc1
    buffer_load_dwordx4 v[88:91], v6, s[44:47], s69 offen offset:0 sc1
    buffer_load_dwordx4 v[92:95], v10, s[44:47], s69 offen offset:0 sc1
    buffer_load_dwordx4 v[96:99], v6, s[44:47], s70 offen offset:0 sc1
    buffer_load_dwordx4 v[100:103], v10, s[44:47], s70 offen offset:0 sc1
    buffer_load_dwordx4 v[104:107], v6, s[44:47], s71 offen offset:0 sc1
    buffer_load_dwordx4 v[108:111], v10, s[44:47], s71 offen offset:0 sc1
    s_cmp_eq_u32 s77, 1
    s_cbranch_scc1 L_wo_c
    ds_read_b32 v4, v2 offset:16
    s_waitcnt lgkmcnt(0)
    v_readfirstlane_b32 s11, v4
    s_nop 0
    s_cmp_lt_u32 s11, 3
    s_cbranch_scc1 L_wo_c
    ds_read_b64_tr_b16 v[16:17], v8 offset:0
    ds_read_b64_tr_b16 v[18:19], v8 offset:128
    ds_read_b64_tr_b16 v[20:21], v8 offset:16384
    ds_read_b64_tr_b16 v[22:23], v8 offset:16512
    ds_read_b64_tr_b16 v[24:25], v8 offset:4096
    ds_read_b64_tr_b16 v[26:27], v8 offset:4224
    ds_read_b64_tr_b16 v[28:29], v8 offset:20480
    ds_read_b64_tr_b16 v[30:31], v8 offset:20608
    ds_read_b64_tr_b16 v[32:33], v8 offset:8192
    ds_read_b64_tr_b16 v[34:35], v8 offset:8320
    ds_read_b64_tr_b16 v[36:37], v8 offset:24576
    ds_read_b64_tr_b16 v[38:39], v8 offset:24704
    ds_read_b64_tr_b16 v[40:41], v8 offset:12288
    ds_read_b64_tr_b16 v[42:43], v8 offset:12416
    ds_read_b64_tr_b16 v[44:45], v8 offset:28672
    ds_read_b64_tr_b16 v[46:47], v8 offset:28800
    ds_read_b64_tr_b16 v[48:49], v9 offset:0
    ds_read_b64_tr_b16 v[50:51], v9 offset:128
    ds_read_b64_tr_b16 v[52:53], v9 offset:16384
    ds_read_b64_tr_b16 v[54:55], v9 offset:16512
    ds_read_b64_tr_b16 v[56:57], v9 offset:4096
    ds_read_b64_tr_b16 v[58:59], v9 offset:4224
    ds_read_b64_tr_b16 v[60:61], v9 offset:20480
    ds_read_b64_tr_b16 v[62:63], v9 offset:20608
    ds_read_b64_tr_b16 v[64:65], v9 offset:8192
    ds_read_b64_tr_b16 v[66:67], v9 offset:8320
    ds_read_b64_tr_b16 v[68:69], v9 offset:24576
    ds_read_b64_tr_b16 v[70:71], v9 offset:24704
    ds_read_b64_tr_b16 v[72:73], v9 offset:12288
    ds_read_b64_tr_b16 v[74:75], v9 offset:12416
    ds_read_b64_tr_b16 v[76:77], v9 offset:28672
    ds_read_b64_tr_b16 v[78:79], v9 offset:28800
    s_mov_b32 s77, 1
L_wo_c:
    s_waitcnt vmcnt(7)
    v_max3_u32 v124, v80, v81, 0
    v_max3_u32 v124, v82, v83, v124
    s_waitcnt vmcnt(6)
    v_max3_u32 v124, v84, v85, v124
    v_max3_u32 v124, v86, v87, v124
    s_waitcnt vmcnt(5)
    v_max3_u32 v124, v88, v89, v124
    v_max3_u32 v124, v90, v91, v124
    s_waitcnt vmcnt(4)
    v_max3_u32 v124, v92, v93, v124
    v_max3_u32 v124, v94, v95, v124
    s_waitcnt vmcnt(3)
    v_max3_u32 v124, v96, v97, v124
    v_max3_u32 v124, v98, v99, v124
    s_waitcnt vmcnt(2)
    v_max3_u32 v124, v100, v101, v124
    v_max3_u32 v124, v102, v103, v124
    s_waitcnt vmcnt(1)
    v_max3_u32 v124, v104, v105, v124
    v_max3_u32 v124, v106, v107, v124
    s_waitcnt vmcnt(0)
    v_max3_u32 v124, v108, v109, v124
    v_max3_u32 v124, v110, v111, v124
    v_cmp_eq_u32 vcc, -1, v124
    s_cbranch_vccz L_wo_g
    s_sub_u32 s42, s42, 1
    s_cbranch_scc0 L_wo_p
    s_branch L_abort
L_wo_g:
    v_pk_add_f32 v[80:81], v[80:81], v[84:85]
    v_pk_add_f32 v[82:83], v[82:83], v[86:87]
    v_cvt_pk_bf16_f32 v112, v80, v81
    v_cvt_pk_bf16_f32 v113, v82, v83
    ds_write_b64 v13, v[112:113] offset:12288
    v_pk_add_f32 v[88:89], v[88:89], v[92:93]
    v_pk_add_f32 v[90:91], v[90:91], v[94:95]
    v_cvt_pk_bf16_f32 v114, v88, v89
    v_cvt_pk_bf16_f32 v115, v90, v91
    ds_write_b64 v13, v[114:115] offset:12304
    v_pk_add_f32 v[96:97], v[96:97], v[100:101]
    v_pk_add_f32 v[98:99], v[98:99], v[102:103]
    v_cvt_pk_bf16_f32 v116, v96, v97
    v_cvt_pk_bf16_f32 v117, v98, v99
    ds_write_b64 v13, v[116:117] offset:12320
    v_pk_add_f32 v[104:105], v[104:105], v[108:109]
    v_pk_add_f32 v[106:107], v[106:107], v[110:111]
    v_cvt_pk_bf16_f32 v118, v104, v105
    v_cvt_pk_bf16_f32 v119, v106, v107
    ds_write_b64 v13, v[118:119] offset:12336
    s_waitcnt lgkmcnt(0)
    s_barrier
    s_cmp_eq_u32 s77, 1
    s_cbranch_scc1 L_wo_m0
    ds_read_b128 v[128:131], v7 offset:12288
    ds_read_b64_tr_b16 v[16:17], v8 offset:0
    ds_read_b64_tr_b16 v[18:19], v8 offset:128
    ds_read_b128 v[132:135], v7 offset:12800
    ds_read_b64_tr_b16 v[20:21], v8 offset:16384
    ds_read_b64_tr_b16 v[22:23], v8 offset:16512
    ds_read_b128 v[136:139], v7 offset:13312
    ds_read_b64_tr_b16 v[24:25], v8 offset:4096
    ds_read_b64_tr_b16 v[26:27], v8 offset:4224
    ds_read_b128 v[140:143], v7 offset:13824
    ds_read_b64_tr_b16 v[28:29], v8 offset:20480
    ds_read_b64_tr_b16 v[30:31], v8 offset:20608
    ds_read_b128 v[144:147], v7 offset:14336
    ds_read_b64_tr_b16 v[32:33], v8 offset:8192
    ds_read_b64_tr_b16 v[34:35], v8 offset:8320
    s_waitcnt lgkmcnt(12)
    v_mfma_f32_16x16x32_bf16 v[112:115], v[16:19], v[128:131], 0
    ds_read_b128 v[148:151], v7 offset:14848
    ds_read_b64_tr_b16 v[36:37], v8 offset:24576
    ds_read_b64_tr_b16 v[38:39], v8 offset:24704
    s_waitcnt lgkmcnt(12)
    v_mfma_f32_16x16x32_bf16 v[112:115], v[20:23], v[132:135], v[112:115]
    ds_read_b128 v[152:155], v7 offset:15360
    ds_read_b64_tr_b16 v[40:41], v8 offset:12288
    ds_read_b64_tr_b16 v[42:43], v8 offset:12416
    s_waitcnt lgkmcnt(12)
    v_mfma_f32_16x16x32_bf16 v[112:115], v[24:27], v[136:139], v[112:115]
    ds_read_b128 v[156:159], v7 offset:15872
    ds_read_b64_tr_b16 v[44:45], v8 offset:28672
    ds_read_b64_tr_b16 v[46:47], v8 offset:28800
    s_waitcnt lgkmcnt(12)
    v_mfma_f32_16x16x32_bf16 v[112:115], v[28:31], v[140:143], v[112:115]
    ds_read_b128 v[160:163], v7 offset:16384
    ds_read_b64_tr_b16 v[48:49], v9 offset:0
    ds_read_b64_tr_b16 v[50:51], v9 offset:128
    s_waitcnt lgkmcnt(12)
    v_mfma_f32_16x16x32_bf16 v[112:115], v[32:35], v[144:147], v[112:115]
    ds_read_b128 v[164:167], v7 offset:16896
    ds_read_b64_tr_b16 v[52:53], v9 offset:16384
    ds_read_b64_tr_b16 v[54:55], v9 offset:16512
    s_waitcnt lgkmcnt(12)
    v_mfma_f32_16x16x32_bf16 v[112:115], v[36:39], v[148:151], v[112:115]
    ds_read_b128 v[168:171], v7 offset:17408
    ds_read_b64_tr_b16 v[56:57], v9 offset:4096
    ds_read_b64_tr_b16 v[58:59], v9 offset:4224
    s_waitcnt lgkmcnt(12)
    v_mfma_f32_16x16x32_bf16 v[112:115], v[40:43], v[152:155], v[112:115]
    ds_read_b128 v[172:175], v7 offset:17920
    ds_read_b64_tr_b16 v[60:61], v9 offset:20480
    ds_read_b64_tr_b16 v[62:63], v9 offset:20608
    s_waitcnt lgkmcnt(12)
    v_mfma_f32_16x16x32_bf16 v[112:115], v[44:47], v[156:159], v[112:115]
    ds_read_b128 v[176:179], v7 offset:18432
    ds_read_b64_tr_b16 v[64:65], v9 offset:8192
    ds_read_b64_tr_b16 v[66:67], v9 offset:8320
    s_waitcnt lgkmcnt(12)
    v_mfma_f32_16x16x32_bf16 v[112:115], v[48:51], v[160:163], v[112:115]
    ds_read_b128 v[180:183], v7 offset:18944
    ds_read_b64_tr_b16 v[68:69], v9 offset:24576
    ds_read_b64_tr_b16 v[70:71], v9 offset:24704
    s_waitcnt lgkmcnt(12)
    v_mfma_f32_16x16x32_bf16 v[112:115], v[52:55], v[164:167], v[112:115]
    ds_read_b128 v[184:187], v7 offset:19456
    ds_read_b64_tr_b16 v[72:73], v9 offset:12288
    ds_read_b64_tr_b16 v[74:75], v9 offset:12416
    s_waitcnt lgkmcnt(12)
    v_mfma_f32_16x16x32_bf16 v[112:115], v[56:59], v[168:171], v[112:115]
    ds_read_b128 v[188:191], v7 offset:19968
    ds_read_b64_tr_b16 v[76:77], v9 offset:28672
    ds_read_b64_tr_b16 v[78:79], v9 offset:28800
    s_waitcnt lgkmcnt(12)
    v_mfma_f32_16x16x32_bf16 v[112:115], v[60:63], v[172:175], v[112:115]
    s_waitcnt lgkmcnt(9)
    v_mfma_f32_16x16x32_bf16 v[112:115], v[64:67], v[176:179], v[112:115]
    s_waitcnt lgkmcnt(6)
    v_mfma_f32_16x16x32_bf16 v[112:115], v[68:71], v[180:183], v[112:115]
    s_waitcnt lgkmcnt(3)
    v_mfma_f32_16x16x32_bf16 v[112:115], v[72:75], v[184:187], v[112:115]
    s_waitcnt lgkmcnt(0)
    v_mfma_f32_16x16x32_bf16 v[112:115], v[76:79], v[188:191], v[112:115]
    s_branch L_wo_s
L_wo_m0:
    ds_read_b128 v[128:131], v7 offset:12288
    ds_read_b128 v[132:135], v7 offset:12800
    ds_read_b128 v[136:139], v7 offset:13312
    ds_read_b128 v[140:143], v7 offset:13824
    ds_read_b128 v[144:147], v7 offset:14336
    ds_read_b128 v[148:151], v7 offset:14848
    ds_read_b128 v[152:155], v7 offset:15360
    ds_read_b128 v[156:159], v7 offset:15872
    ds_read_b128 v[160:163], v7 offset:16384
    ds_read_b128 v[164:167], v7 offset:16896
    ds_read_b128 v[168:171], v7 offset:17408
    ds_read_b128 v[172:175], v7 offset:17920
    ds_read_b128 v[176:179], v7 offset:18432
    ds_read_b128 v[180:183], v7 offset:18944
    ds_read_b128 v[184:187], v7 offset:19456
    ds_read_b128 v[188:191], v7 offset:19968
    s_waitcnt lgkmcnt(15)
    v_mfma_f32_16x16x32_bf16 v[112:115], v[16:19], v[128:131], 0
    s_waitcnt lgkmcnt(14)
    v_mfma_f32_16x16x32_bf16 v[112:115], v[20:23], v[132:135], v[112:115]
    s_waitcnt lgkmcnt(13)
    v_mfma_f32_16x16x32_bf16 v[112:115], v[24:27], v[136:139], v[112:115]
    s_waitcnt lgkmcnt(12)
    v_mfma_f32_16x16x32_bf16 v[112:115], v[28:31], v[140:143], v[112:115]
    s_waitcnt lgkmcnt(11)
    v_mfma_f32_16x16x32_bf16 v[112:115], v[32:35], v[144:147], v[112:115]
    s_waitcnt lgkmcnt(10)
    v_mfma_f32_16x16x32_bf16 v[112:115], v[36:39], v[148:151], v[112:115]
    s_waitcnt lgkmcnt(9)
    v_mfma_f32_16x16x32_bf16 v[112:115], v[40:43], v[152:155], v[112:115]
    s_waitcnt lgkmcnt(8)
    v_mfma_f32_16x16x32_bf16 v[112:115], v[44:47], v[156:159], v[112:115]
    s_waitcnt lgkmcnt(7)
    v_mfma_f32_16x16x32_bf16 v[112:115], v[48:51], v[160:163], v[112:115]
    s_waitcnt lgkmcnt(6)
    v_mfma_f32_16x16x32_bf16 v[112:115], v[52:55], v[164:167], v[112:115]
    s_waitcnt lgkmcnt(5)
    v_mfma_f32_16x16x32_bf16 v[112:115], v[56:59], v[168:171], v[112:115]
    s_waitcnt lgkmcnt(4)
    v_mfma_f32_16x16x32_bf16 v[112:115], v[60:63], v[172:175], v[112:115]
    s_waitcnt lgkmcnt(3)
    v_mfma_f32_16x16x32_bf16 v[112:115], v[64:67], v[176:179], v[112:115]
    s_waitcnt lgkmcnt(2)
    v_mfma_f32_16x16x32_bf16 v[112:115], v[68:71], v[180:183], v[112:115]
    s_waitcnt lgkmcnt(1)
    v_mfma_f32_16x16x32_bf16 v[112:115], v[72:75], v[184:187], v[112:115]
    s_waitcnt lgkmcnt(0)
    v_mfma_f32_16x16x32_bf16 v[112:115], v[76:79], v[188:191], v[112:115]
L_wo_s:
    s_nop 7
    v_min_u32 v112, -2, v112
    v_min_u32 v113, -2, v113
    v_min_u32 v114, -2, v114
    v_min_u32 v115, -2, v115
    s_mov_b32 exec_lo, 0x00ff00ff
    s_mov_b32 exec_hi, 0x00ff00ff
    buffer_store_dwordx4 v[112:115], v15, s[44:47], s75 offen offset:0 sc1
    s_mov_b64 exec, 1
    ds_add_u32 v2, v3 offset:36
    s_mov_b64 exec, -1
    s_mov_b64 exec, -1
    v_bfe_u32 v10, v1, 1, 3
    v_lshlrev_b32 v10, 4, v10
    v_lshrrev_b32 v11, 5, v1
    v_lshl_add_u32 v10, v11, 7, v10
    v_bfe_u32 v11, v1, 4, 1
    v_lshl_add_u32 v10, v11, 9, v10
    v_and_b32 v11, 1, v1
    v_lshl_add_u32 v10, v11, 8, v10
    s_lshl_b32 s11, s12, 10
    s_add_u32 s14, s13, s11
    s_add_u32 s14, s14, 1835008
    s_add_u32 s15, s14, 9216
    s_add_u32 s70, s14, 4096
    s_add_u32 s71, s15, 4096
    s_add_u32 s72, s13, 1843200
    s_add_u32 s73, s72, 9216
    s_lshl_b32 s11, s12, 10
    v_add_u32 v13, s11, v10
    v_lshrrev_b32 v11, 4, v1
    v_bfe_u32 v12, v1, 2, 2
    v_lshl_add_u32 v8, v11, 3, v12
    v_lshlrev_b32 v8, 7, v8
    v_and_b32 v11, 1, v11
    v_lshlrev_b32 v11, 6, v11
    v_and_b32 v12, 2, v12
    v_lshl_add_u32 v11, v12, 4, v11
    v_and_b32 v12, 3, v1
    v_lshlrev_b32 v12, 3, v12
    v_xor_b32 v11, v11, v12
    v_add_u32 v8, v8, v11
    s_lshl_b32 s11, s12, 5
    v_xor_b32 v8, s11, v8
    v_add_u32 v8, 90112, v8
    v_add_u32 v9, 0x8000, v8
    s_mov_b32 s77, 0
Lfw_33:
    ds_read_b32 v4, v2 offset:20
    s_waitcnt lgkmcnt(0)
    v_readfirstlane_b32 s11, v4
    s_nop 0
    s_cmp_ge_u32 s11, 1
    s_cbranch_scc1 Lfd_34
    s_sleep 2
    s_sub_u32 s42, s42, 1
    s_cbranch_scc0 Lfw_33
    s_branch L_abort
Lfd_34:
L_f2_p:
    buffer_load_dwordx4 v[88:91], v6, s[44:47], s14 offen offset:0 sc1
    buffer_load_dwordx4 v[92:95], v6, s[44:47], s15 offen offset:0 sc1
    buffer_load_dwordx4 v[96:99], v6, s[44:47], s70 offen offset:0 sc1
    buffer_load_dwordx4 v[100:103], v6, s[44:47], s71 offen offset:0 sc1
    buffer_load_dwordx4 v[104:107], v6, s[44:47], s72 offen offset:0 sc1
    buffer_load_dwordx4 v[108:111], v6, s[44:47], s73 offen offset:0 sc1
    s_cmp_eq_u32 s77, 1
    s_cbranch_scc1 L_f2_c
    ds_read_b32 v4, v2 offset:20
    s_waitcnt lgkmcnt(0)
    v_readfirstlane_b32 s11, v4
    s_nop 0
    s_cmp_lt_u32 s11, 3
    s_cbranch_scc1 L_f2_c
    ds_read_b64_tr_b16 v[16:17], v8 offset:0
    ds_read_b64_tr_b16 v[18:19], v8 offset:512
    ds_read_b64_tr_b16 v[20:21], v8 offset:4096
    ds_read_b64_tr_b16 v[22:23], v8 offset:4608
    ds_read_b64_tr_b16 v[24:25], v8 offset:8192
    ds_read_b64_tr_b16 v[26:27], v8 offset:8704
    ds_read_b64_tr_b16 v[28:29], v8 offset:12288
    ds_read_b64_tr_b16 v[30:31], v8 offset:12800
    ds_read_b64_tr_b16 v[32:33], v8 offset:16384
    ds_read_b64_tr_b16 v[34:35], v8 offset:16896
    ds_read_b64_tr_b16 v[36:37], v8 offset:20480
    ds_read_b64_tr_b16 v[38:39], v8 offset:20992
    ds_read_b64_tr_b16 v[40:41], v8 offset:24576
    ds_read_b64_tr_b16 v[42:43], v8 offset:25088
    ds_read_b64_tr_b16 v[44:45], v8 offset:28672
    ds_read_b64_tr_b16 v[46:47], v8 offset:29184
    ds_read_b64_tr_b16 v[48:49], v9 offset:0
    ds_read_b64_tr_b16 v[50:51], v9 offset:512
    ds_read_b64_tr_b16 v[52:53], v9 offset:4096
    ds_read_b64_tr_b16 v[54:55], v9 offset:4608
    ds_read_b64_tr_b16 v[56:57], v9 offset:8192
    ds_read_b64_tr_b16 v[58:59], v9 offset:8704
    ds_read_b64_tr_b16 v[60:61], v9 offset:12288
    ds_read_b64_tr_b16 v[62:63], v9 offset:12800
    ds_read_b64_tr_b16 v[64:65], v9 offset:16384
    ds_read_b64_tr_b16 v[66:67], v9 offset:16896
    ds_read_b64_tr_b16 v[68:69], v9 offset:20480
    ds_read_b64_tr_b16 v[70:71], v9 offset:20992
    ds_read_b64_tr_b16 v[72:73], v9 offset:24576
    ds_read_b64_tr_b16 v[74:75], v9 offset:25088
    ds_read_b64_tr_b16 v[76:77], v9 offset:28672
    ds_read_b64_tr_b16 v[78:79], v9 offset:29184
    ds_read_b64_tr_b16 v[80:81], v9 offset:32768
    ds_read_b64_tr_b16 v[82:83], v9 offset:33280
    ds_read_b64_tr_b16 v[84:85], v9 offset:36864
    ds_read_b64_tr_b16 v[86:87], v9 offset:37376
    s_mov_b32 s77, 1
L_f2_c:
    s_waitcnt vmcnt(5)
    v_max3_u32 v124, v88, v89, 0
    v_max3_u32 v124, v90, v91, v124
    s_waitcnt vmcnt(4)
    v_max3_u32 v124, v92, v93, v124
    v_max3_u32 v124, v94, v95, v124
    s_waitcnt vmcnt(3)
    v_max3_u32 v124, v96, v97, v124
    v_max3_u32 v124, v98, v99, v124
    s_waitcnt vmcnt(2)
    v_max3_u32 v124, v100, v101, v124
    v_max3_u32 v124, v102, v103, v124
    s_waitcnt vmcnt(1)
    v_max3_u32 v124, v104, v105, v124
    v_max3_u32 v124, v106, v107, v124
    s_waitcnt vmcnt(0)
    v_max3_u32 v124, v108, v109, v124
    v_max3_u32 v124, v110, v111, v124
    v_cmp_eq_u32 vcc, -1, v124
    s_cbranch_vccz L_f2_g
    s_sub_u32 s42, s42, 1
    s_cbranch_scc0 L_f2_p
    s_branch L_abort
L_f2_g:
    v_lshlrev_b32 v128, 16, v88
    v_and_b32 v129, s76, v88
    v_lshlrev_b32 v130, 16, v92
    v_and_b32 v131, s76, v92
    v_lshlrev_b32 v132, 16, v89
    v_and_b32 v133, s76, v89
    v_lshlrev_b32 v134, 16, v93
    v_and_b32 v135, s76, v93
    v_lshlrev_b32 v136, 16, v90
    v_and_b32 v137, s76, v90
    v_lshlrev_b32 v138, 16, v94
    v_and_b32 v139, s76, v94
    v_lshlrev_b32 v140, 16, v91
    v_and_b32 v141, s76, v91
    v_lshlrev_b32 v142, 16, v95
    v_and_b32 v143, s76, v95
    v_pk_mul_f32 v[128:129], v[128:129], v[130:131]
    v_pk_mul_f32 v[132:133], v[132:133], v[134:135]
    v_pk_mul_f32 v[136:137], v[136:137], v[138:139]
    v_pk_mul_f32 v[140:141], v[140:141], v[142:143]
    v_cvt_pk_bf16_f32 v88, v128, v129
    v_cvt_pk_bf16_f32 v89, v132, v133
    v_cvt_pk_bf16_f32 v90, v136, v137
    v_cvt_pk_bf16_f32 v91, v140, v141
    ds_write_b128 v13, v[88:91] offset:12288
    v_lshlrev_b32 v128, 16, v96
    v_and_b32 v129, s76, v96
    v_lshlrev_b32 v130, 16, v100
    v_and_b32 v131, s76, v100
    v_lshlrev_b32 v132, 16, v97
    v_and_b32 v133, s76, v97
    v_lshlrev_b32 v134, 16, v101
    v_and_b32 v135, s76, v101
    v_lshlrev_b32 v136, 16, v98
    v_and_b32 v137, s76, v98
    v_lshlrev_b32 v138, 16, v102
    v_and_b32 v139, s76, v102
    v_lshlrev_b32 v140, 16, v99
    v_and_b32 v141, s76, v99
    v_lshlrev_b32 v142, 16, v103
    v_and_b32 v143, s76, v103
    v_pk_mul_f32 v[128:129], v[128:129], v[130:131]
    v_pk_mul_f32 v[132:133], v[132:133], v[134:135]
    v_pk_mul_f32 v[136:137], v[136:137], v[138:139]
    v_pk_mul_f32 v[140:141], v[140:141], v[142:143]
    v_cvt_pk_bf16_f32 v96, v128, v129
    v_cvt_pk_bf16_f32 v97, v132, v133
    v_cvt_pk_bf16_f32 v98, v136, v137
    v_cvt_pk_bf16_f32 v99, v140, v141
    ds_write_b128 v13, v[96:99] offset:16384
    v_lshlrev_b32 v128, 16, v104
    v_and_b32 v129, s76, v104
    v_lshlrev_b32 v130, 16, v108
    v_and_b32 v131, s76, v108
    v_lshlrev_b32 v132, 16, v105
    v_and_b32 v133, s76, v105
    v_lshlrev_b32 v134, 16, v109
    v_and_b32 v135, s76, v109
    v_lshlrev_b32 v136, 16, v106
    v_and_b32 v137, s76, v106
    v_lshlrev_b32 v138, 16, v110
    v_and_b32 v139, s76, v110
    v_lshlrev_b32 v140, 16, v107
    v_and_b32 v141, s76, v107
    v_lshlrev_b32 v142, 16, v111
    v_and_b32 v143, s76, v111
    v_pk_mul_f32 v[128:129], v[128:129], v[130:131]
    v_pk_mul_f32 v[132:133], v[132:133], v[134:135]
    v_pk_mul_f32 v[136:137], v[136:137], v[138:139]
    v_pk_mul_f32 v[140:141], v[140:141], v[142:143]
    v_cvt_pk_bf16_f32 v104, v128, v129
    v_cvt_pk_bf16_f32 v105, v132, v133
    v_cvt_pk_bf16_f32 v106, v136, v137
    v_cvt_pk_bf16_f32 v107, v140, v141
    ds_write_b128 v10, v[104:107] offset:20480
    s_waitcnt lgkmcnt(0)
    s_barrier
    s_cmp_eq_u32 s77, 1
    s_cbranch_scc1 L_f2_m
    ds_read_b128 v[128:131], v6 offset:12288
    ds_read_b64_tr_b16 v[16:17], v8 offset:0
    ds_read_b64_tr_b16 v[18:19], v8 offset:512
    ds_read_b64_tr_b16 v[20:21], v8 offset:4096
    ds_read_b64_tr_b16 v[22:23], v8 offset:4608
    ds_read_b128 v[132:135], v6 offset:13312
    ds_read_b64_tr_b16 v[24:25], v8 offset:8192
    ds_read_b64_tr_b16 v[26:27], v8 offset:8704
    ds_read_b64_tr_b16 v[28:29], v8 offset:12288
    ds_read_b64_tr_b16 v[30:31], v8 offset:12800
    ds_read_b128 v[136:139], v6 offset:14336
    ds_read_b64_tr_b16 v[32:33], v8 offset:16384
    ds_read_b64_tr_b16 v[34:35], v8 offset:16896
    ds_read_b64_tr_b16 v[36:37], v8 offset:20480
    ds_read_b64_tr_b16 v[38:39], v8 offset:20992
    s_waitcnt lgkmcnt(10)
    v_mfma_f32_16x16x32_bf16 v[112:115], v[16:19], v[128:131], 0
    v_mfma_f32_16x16x32_bf16 v[116:119], v[20:23], v[128:131], 0
    ds_read_b128 v[140:143], v6 offset:15360
    ds_read_b64_tr_b16 v[40:41], v8 offset:24576
    ds_read_b64_tr_b16 v[42:43], v8 offset:25088
    ds_read_b64_tr_b16 v[44:45], v8 offset:28672
    ds_read_b64_tr_b16 v[46:47], v8 offset:29184
    s_waitcnt lgkmcnt(10)
    v_mfma_f32_16x16x32_bf16 v[112:115], v[24:27], v[132:135], v[112:115]
    v_mfma_f32_16x16x32_bf16 v[116:119], v[28:31], v[132:135], v[116:119]
    ds_read_b128 v[144:147], v6 offset:16384
    ds_read_b64_tr_b16 v[48:49], v9 offset:0
    ds_read_b64_tr_b16 v[50:51], v9 offset:512
    ds_read_b64_tr_b16 v[52:53], v9 offset:4096
    ds_read_b64_tr_b16 v[54:55], v9 offset:4608
    s_waitcnt lgkmcnt(10)
    v_mfma_f32_16x16x32_bf16 v[112:115], v[32:35], v[136:139], v[112:115]
    v_mfma_f32_16x16x32_bf16 v[116:119], v[36:39], v[136:139], v[116:119]
    ds_read_b128 v[148:151], v6 offset:17408
    ds_read_b64_tr_b16 v[56:57], v9 offset:8192
    ds_read_b64_tr_b16 v[58:59], v9 offset:8704
    ds_read_b64_tr_b16 v[60:61], v9 offset:12288
    ds_read_b64_tr_b16 v[62:63], v9 offset:12800
    s_waitcnt lgkmcnt(10)
    v_mfma_f32_16x16x32_bf16 v[112:115], v[40:43], v[140:143], v[112:115]
    v_mfma_f32_16x16x32_bf16 v[116:119], v[44:47], v[140:143], v[116:119]
    ds_read_b128 v[152:155], v6 offset:18432
    ds_read_b64_tr_b16 v[64:65], v9 offset:16384
    ds_read_b64_tr_b16 v[66:67], v9 offset:16896
    ds_read_b64_tr_b16 v[68:69], v9 offset:20480
    ds_read_b64_tr_b16 v[70:71], v9 offset:20992
    s_waitcnt lgkmcnt(10)
    v_mfma_f32_16x16x32_bf16 v[112:115], v[48:51], v[144:147], v[112:115]
    v_mfma_f32_16x16x32_bf16 v[116:119], v[52:55], v[144:147], v[116:119]
    ds_read_b128 v[156:159], v6 offset:19456
    ds_read_b64_tr_b16 v[72:73], v9 offset:24576
    ds_read_b64_tr_b16 v[74:75], v9 offset:25088
    ds_read_b64_tr_b16 v[76:77], v9 offset:28672
    ds_read_b64_tr_b16 v[78:79], v9 offset:29184
    s_waitcnt lgkmcnt(10)
    v_mfma_f32_16x16x32_bf16 v[112:115], v[56:59], v[148:151], v[112:115]
    v_mfma_f32_16x16x32_bf16 v[116:119], v[60:63], v[148:151], v[116:119]
    ds_read_b128 v[160:163], v6 offset:20480
    ds_read_b64_tr_b16 v[80:81], v9 offset:32768
    ds_read_b64_tr_b16 v[82:83], v9 offset:33280
    ds_read_b64_tr_b16 v[84:85], v9 offset:36864
    ds_read_b64_tr_b16 v[86:87], v9 offset:37376
    s_waitcnt lgkmcnt(10)
    v_mfma_f32_16x16x32_bf16 v[112:115], v[64:67], v[152:155], v[112:115]
    v_mfma_f32_16x16x32_bf16 v[116:119], v[68:71], v[152:155], v[116:119]
    s_waitcnt lgkmcnt(5)
    v_mfma_f32_16x16x32_bf16 v[112:115], v[72:75], v[156:159], v[112:115]
    v_mfma_f32_16x16x32_bf16 v[116:119], v[76:79], v[156:159], v[116:119]
    s_waitcnt lgkmcnt(0)
    v_mfma_f32_16x16x32_bf16 v[112:115], v[80:83], v[160:163], v[112:115]
    v_mfma_f32_16x16x32_bf16 v[116:119], v[84:87], v[160:163], v[116:119]
    s_branch L_f2_s
L_f2_m:
    ds_read_b128 v[128:131], v6 offset:12288
    ds_read_b128 v[132:135], v6 offset:13312
    ds_read_b128 v[136:139], v6 offset:14336
    ds_read_b128 v[140:143], v6 offset:15360
    ds_read_b128 v[144:147], v6 offset:16384
    ds_read_b128 v[148:151], v6 offset:17408
    ds_read_b128 v[152:155], v6 offset:18432
    ds_read_b128 v[156:159], v6 offset:19456
    ds_read_b128 v[160:163], v6 offset:20480
    s_waitcnt lgkmcnt(8)
    v_mfma_f32_16x16x32_bf16 v[112:115], v[16:19], v[128:131], 0
    v_mfma_f32_16x16x32_bf16 v[116:119], v[20:23], v[128:131], 0
    s_waitcnt lgkmcnt(7)
    v_mfma_f32_16x16x32_bf16 v[112:115], v[24:27], v[132:135], v[112:115]
    v_mfma_f32_16x16x32_bf16 v[116:119], v[28:31], v[132:135], v[116:119]
    s_waitcnt lgkmcnt(6)
    v_mfma_f32_16x16x32_bf16 v[112:115], v[32:35], v[136:139], v[112:115]
    v_mfma_f32_16x16x32_bf16 v[116:119], v[36:39], v[136:139], v[116:119]
    s_waitcnt lgkmcnt(5)
    v_mfma_f32_16x16x32_bf16 v[112:115], v[40:43], v[140:143], v[112:115]
    v_mfma_f32_16x16x32_bf16 v[116:119], v[44:47], v[140:143], v[116:119]
    s_waitcnt lgkmcnt(4)
    v_mfma_f32_16x16x32_bf16 v[112:115], v[48:51], v[144:147], v[112:115]
    v_mfma_f32_16x16x32_bf16 v[116:119], v[52:55], v[144:147], v[116:119]
    s_waitcnt lgkmcnt(3)
    v_mfma_f32_16x16x32_bf16 v[112:115], v[56:59], v[148:151], v[112:115]
    v_mfma_f32_16x16x32_bf16 v[116:119], v[60:63], v[148:151], v[116:119]
    s_waitcnt lgkmcnt(2)
    v_mfma_f32_16x16x32_bf16 v[112:115], v[64:67], v[152:155], v[112:115]
    v_mfma_f32_16x16x32_bf16 v[116:119], v[68:71], v[152:155], v[116:119]
    s_waitcnt lgkmcnt(1)
    v_mfma_f32_16x16x32_bf16 v[112:115], v[72:75], v[156:159], v[112:115]
    v_mfma_f32_16x16x32_bf16 v[116:119], v[76:79], v[156:159], v[116:119]
    s_waitcnt lgkmcnt(0)
    v_mfma_f32_16x16x32_bf16 v[112:115], v[80:83], v[160:163], v[112:115]
    v_mfma_f32_16x16x32_bf16 v[116:119], v[84:87], v[160:163], v[116:119]
L_f2_s:
    s_nop 7
    v_add_f32_dpp v112, v116, v112 row_ror:8 row_mask:0xf bank_mask:0xf
    v_add_f32_dpp v113, v117, v113 row_ror:8 row_mask:0xf bank_mask:0xf
    v_add_f32_dpp v114, v118, v114 row_ror:8 row_mask:0xf bank_mask:0xf
    v_add_f32_dpp v115, v119, v115 row_ror:8 row_mask:0xf bank_mask:0xf
    v_min_u32 v112, -2, v112
    v_min_u32 v113, -2, v113
    v_min_u32 v114, -2, v114
    v_min_u32 v115, -2, v115
    s_mov_b32 exec_lo, 0x00ff00ff
    s_mov_b32 exec_hi, 0x00ff00ff
    buffer_store_dwordx4 v[112:115], v15, s[44:47], s74 offen offset:0 sc1
    s_branch L_fin
L_r_w0:
    s_cmp_ge_u32 s5, 18
    s_cbranch_scc1 L_nlg
    s_lshl_b32 s61, s4, 7
    s_add_u32 s61, s61, 2433024
Lfw_35:
    ds_read_b32 v4, v2 offset:12
    s_waitcnt lgkmcnt(0)
    v_readfirstlane_b32 s11, v4
    s_nop 0
    s_cmp_ge_u32 s11, 5
    s_cbranch_scc1 Lfd_36
    s_sleep 4
    s_sub_u32 s42, s42, 1
    s_cbranch_scc0 Lfw_35
    s_branch L_abort
Lfd_36:
L_lgp:
    s_load_dword s60, s[40:41], s61 glc
    s_waitcnt lgkmcnt(0)
    s_cmp_eq_u32 s60, s26
    s_cbranch_scc1 L_lgd
    s_sleep 3
    s_sub_u32 s42, s42, 1
    s_cbranch_scc0 L_lgp
    s_branch L_abort
L_lgd:
    s_mov_b64 exec, 1
    ds_add_u32 v2, v3 offset:28
    s_mov_b64 exec, -1
    s_branch L_fin
L_nlg:
    s_sub_u32 s12, s5, 18
    s_cmp_ge_u32 s12, 9
    s_cbranch_scc1 L_fin
    s_mov_b32 s60, s26
    s_lshl_b32 s61, s4, 2
    s_add_u32 s61, s61, 2428928
    s_barrier
    s_cmp_lg_u32 s5, 18
    s_cbranch_scc1 L_nsh
    s_atomic_swap s60, s[40:41], s61 offset:0
    s_atomic_swap s60, s[40:41], s61 offset:128
    s_atomic_swap s60, s[40:41], s61 offset:256
    s_atomic_swap s60, s[40:41], s61 offset:384
    s_atomic_swap s60, s[40:41], s61 offset:512
    s_atomic_swap s60, s[40:41], s61 offset:640
    s_atomic_swap s60, s[40:41], s61 offset:768
    s_atomic_swap s60, s[40:41], s61 offset:896
    s_lshl_b32 s61, s4, 7
    s_add_u32 s61, s61, 2433024
    s_atomic_swap s60, s[40:41], s61
L_nsh:
    v_and_b32 v8, 15, v1
    v_lshlrev_b32 v9, 3, v8
    s_mul_i32 s14, s4, 1152
    s_lshl_b32 s11, s12, 7
    s_add_u32 s72, s14, s11
    s_add_u32 s14, s72, s13
    s_add_u32 s14, s14, 1572864
    s_add_u32 s15, s14, 9216
    s_lshl_b32 s73, s4, 4
    s_add_u32 s73, s73, s13
    s_add_u32 s73, s73, 1591296
Lfw_37:
    ds_read_b32 v4, v2 offset:20
    s_waitcnt lgkmcnt(0)
    v_readfirstlane_b32 s11, v4
    s_nop 0
    s_cmp_ge_u32 s11, 3
    s_cbranch_scc1 Lfd_38
    s_sleep 8
    s_sub_u32 s42, s42, 1
    s_cbranch_scc0 Lfw_37
    s_branch L_abort
Lfd_38:
Lp_39:
    s_sleep 8
    buffer_load_dwordx2 v[16:17], v9, s[44:47], s14 offen offset:0 sc1
    buffer_load_dwordx2 v[18:19], v9, s[44:47], s15 offen offset:0 sc1
    s_waitcnt vmcnt(1)
    v_max3_u32 v124, v16, v17, 0
    s_waitcnt vmcnt(0)
    v_max3_u32 v124, v18, v19, v124
    v_cmp_eq_u32 vcc, -1, v124
    s_cbranch_vccz Lpd_40
    s_sub_u32 s42, s42, 1
    s_cbranch_scc0 Lp_39
    s_branch L_abort
Lpd_40:
Lp_41:
    s_sleep 2
    buffer_load_dword v20, v2, s[44:47], s73 offen offset:0 sc1
    s_waitcnt vmcnt(0)
    v_max_u32 v124, 0, v20
    v_cmp_eq_u32 vcc, -1, v124
    s_cbranch_vccz Lpd_42
    s_sub_u32 s42, s42, 1
    s_cbranch_scc0 Lp_41
    s_branch L_abort
Lpd_42:
    v_lshlrev_b32 v24, 16, v16
    v_and_b32 v25, s76, v16
    v_lshlrev_b32 v26, 16, v17
    v_and_b32 v27, s76, v17
    v_lshlrev_b32 v28, 16, v18
    v_and_b32 v29, s76, v18
    v_lshlrev_b32 v30, 16, v19
    v_and_b32 v31, s76, v19
    v_and_b32 v10, 15, v1
    v_mul_u32_u24 v10, 16, v10
    v_lshrrev_b32 v11, 4, v1
    v_mul_u32_u24 v11, 18432, v11
    v_add_u32 v10, v10, v11
    s_mul_i32 s14, s4, 2304
    s_lshl_b32 s11, s12, 8
    s_add_u32 s14, s14, s11
    s_add_u32 s14, s14, 2097152
    s_add_u32 s15, s14, 73728
    s_mov_b32 s64, s36
    s_and_b32 s65, s37, 0xffff
    s_mov_b32 s66, 9216
    s_mov_b32 s67, 0x20000
    v_mov_b32 v21, v20
    s_barrier
    s_sleep 13
Lp_43:
    buffer_load_dwordx4 v[32:35], v10, s[44:47], s14 offen offset:0 sc1
    buffer_load_dwordx4 v[36:39], v10, s[44:47], s15 offen offset:0 sc1
    s_waitcnt vmcnt(1)
    v_max3_u32 v124, v32, v33, 0
    v_max3_u32 v124, v34, v35, v124
    s_waitcnt vmcnt(0)
    v_max3_u32 v124, v36, v37, v124
    v_max3_u32 v124, v38, v39, v124
    v_cmp_eq_u32 vcc, -1, v124
    s_cbranch_vccz Lpd_44
    s_sub_u32 s42, s42, 1
    s_cbranch_scc0 Lp_43
    s_branch L_abort
Lpd_44:
L_fin_g:
    v_pk_add_f32 v[32:33], v[32:33], v[36:37]
    v_pk_add_f32 v[34:35], v[34:35], v[38:39]
    v_mov_b32 v36, v32
    v_mov_b32 v37, v33
    v_mov_b32 v38, v34
    v_mov_b32 v39, v35
    v_permlane16_swap_b32 v32, v36
    v_permlane16_swap_b32 v33, v37
    v_permlane16_swap_b32 v34, v38
    v_permlane16_swap_b32 v35, v39
    v_pk_add_f32 v[32:33], v[32:33], v[36:37]
    v_pk_add_f32 v[34:35], v[34:35], v[38:39]
    v_mov_b32 v36, v32
    v_mov_b32 v37, v33
    v_mov_b32 v38, v34
    v_mov_b32 v39, v35
    v_permlane32_swap_b32 v32, v36
    v_permlane32_swap_b32 v33, v37
    v_permlane32_swap_b32 v34, v38
    v_permlane32_swap_b32 v35, v39
    v_pk_add_f32 v[32:33], v[32:33], v[36:37]
    v_pk_add_f32 v[34:35], v[34:35], v[38:39]
    v_cvt_pk_bf16_f32 v40, v32, v33
    v_cvt_pk_bf16_f32 v41, v34, v35
    v_lshlrev_b32 v32, 16, v40
    v_and_b32 v33, s76, v40
    v_lshlrev_b32 v34, 16, v41
    v_and_b32 v35, s76, v41
    v_pk_mul_f32 v[32:33], v[32:33], v[20:21]
    v_pk_mul_f32 v[34:35], v[34:35], v[20:21]
    v_cvt_pk_bf16_f32 v40, v32, v33
    v_cvt_pk_bf16_f32 v41, v34, v35
    v_lshlrev_b32 v32, 16, v40
    v_and_b32 v33, s76, v40
    v_lshlrev_b32 v34, 16, v41
    v_and_b32 v35, s76, v41
    v_pk_add_f32 v[32:33], v[24:25], v[32:33]
    v_pk_add_f32 v[34:35], v[26:27], v[34:35]
    v_cvt_pk_bf16_f32 v40, v32, v33
    v_cvt_pk_bf16_f32 v41, v34, v35
    v_lshlrev_b32 v32, 16, v40
    v_and_b32 v33, s76, v40
    v_lshlrev_b32 v34, 16, v41
    v_and_b32 v35, s76, v41
    v_pk_add_f32 v[32:33], v[28:29], v[32:33]
    v_pk_add_f32 v[34:35], v[30:31], v[34:35]
    v_cvt_pk_bf16_f32 v40, v32, v33
    v_cvt_pk_bf16_f32 v41, v34, v35
    s_mov_b64 exec, 0xffff
    buffer_store_dwordx2 v[40:41], v9, s[64:67], s72 offen
    s_cmp_eq_u32 s2, 144
    s_cbranch_scc0 L_fin
    v_mov_b32 v42, s26
    v_mov_b32 v43, s27
    s_mov_b32 s11, 2359296
    s_mov_b64 exec, 1
    buffer_store_dwordx2 v[42:43], v2, s[44:47], s11 offen sc1
    s_branch L_fin
L_abort:
L_fin:
L_end:

    s_endpgm
.section .rodata,"a"
.p2align 6
.amdhsa_kernel sequential_preLN__sliding_block_cached__moe_arch_mod__decode_kernel
  .amdhsa_next_free_vgpr 256
  .amdhsa_next_free_sgpr 102
  .amdhsa_accum_offset 256
  .amdhsa_group_segment_fixed_size 0
  .amdhsa_kernarg_size 104
  .amdhsa_user_sgpr_count 2
  .amdhsa_user_sgpr_kernarg_segment_ptr 1
  .amdhsa_system_sgpr_workgroup_id_x 1
  .amdhsa_float_denorm_mode_32 3
.end_amdhsa_kernel
```
